```python
import torch

def _softmax(x, axis=-1):
    return torch.softmax(x, dim=axis)

def _gelu(x):
    return torch.nn.functional.gelu(x, approximate='tanh')

def _silu(x):
    return torch.nn.functional.silu(x)

def _sigmoid(x):
    return torch.sigmoid(x)

def _layernorm(x, axis=-1, eps=1e-05):
    m = x.mean(dim=axis, keepdim=True)
    v = x.var(dim=axis, keepdim=True, unbiased=False)
    return (x - m) / torch.sqrt(v + eps)

def _scatter_add(tgt, idx, src, axis=0):
    return tgt.clone().index_add_(axis, idx, src)

def _segment_sum(src, seg, n):
    out = torch.zeros((n,) + src.shape[1:], dtype=src.dtype)
    return out.index_add_(0, seg, src)

def _pad(x, pw):
    flat = tuple((v for pair in reversed(pw) for v in pair))
    return torch.nn.functional.pad(x, flat)
kernel_name = 'adaLN_cond__mha_block_cached__geglu_ffn__decode'

def setup_inputs():

    _w = lambda a: (lambda t: t.to(torch.bfloat16) if t.is_floating_point() else t)(torch.as_tensor(a))

    def _A_setup():
        B, Sq, D = (2, 1, 448)
        H, Sk, Dh = (16, 4096, 256)
        return {'x': _w((lambda *s: torch.randn(*s, dtype=torch.bfloat16) * 0.1)(B, Sq, D)), 'k_cache': _w((lambda *s: torch.randn(*s, dtype=torch.bfloat16) * 0.8)(B, H, Sk, Dh)), 'v_cache': _w((lambda *s: torch.randn(*s, dtype=torch.bfloat16) * 0.8)(B, H, Sk, Dh)), 'wq': _w((lambda *s: torch.randn(*s, dtype=torch.bfloat16) * 0.8)(D, H * Dh) * D ** (-0.5)), 'wo': _w((lambda *s: torch.randn(*s, dtype=torch.bfloat16) * 0.8)(H * Dh, D) * (H * Dh) ** (-0.5))}
    _A_in = _A_setup()

    def _B_setup():
        B, S, D, F = (2, 1, 448, 1792)
        return {'x': _w((lambda *s: torch.randn(*s, dtype=torch.bfloat16) * 0.1)(B, S, D)), 'w_gate': _w((lambda *s: torch.randn(*s, dtype=torch.bfloat16) * 0.1)(D, F)), 'w_up': _w((lambda *s: torch.randn(*s, dtype=torch.bfloat16) * 0.1)(D, F)), 'w_down': _w((lambda *s: torch.randn(*s, dtype=torch.bfloat16) * 0.1)(F, D))}
    _B_in = _B_setup()
    return {'A_x': _A_in['x'], 'A_k_cache': _A_in['k_cache'], 'A_v_cache': _A_in['v_cache'], 'A_wq': _A_in['wq'], 'A_wo': _A_in['wo'], 'B_x': _B_in['x'], 'B_w_gate': _B_in['w_gate'], 'B_w_up': _B_in['w_up'], 'B_w_down': _B_in['w_down'], 'c': _w((lambda *s: torch.randn(*s, dtype=torch.bfloat16) * 0.8)(2, 448) * 8.0), 'w_mod': _w((lambda *s: torch.randn(*s, dtype=torch.bfloat16) * 0.8)(448, 6 * 448) * 448 ** (-0.5) * 8.0)}

def reference(A_x, A_k_cache, A_v_cache, A_wq, A_wo, B_x, B_w_gate, B_w_up, B_w_down, c, w_mod):

    def _A_ref(x, k_cache, v_cache, wq, wo):
        B, Sq, D = x.shape
        H, Dh = (16, 256)
        q = (lambda x, *d: x.permute(*d))((x @ wq).reshape(B, Sq, H, Dh), 0, 2, 1, 3)
        scores = torch.einsum('bhqd,bhkd->bhqk', q, k_cache) * Dh ** (-0.5)
        p = _softmax(scores, axis=-1)
        o = torch.einsum('bhqk,bhkd->bhqd', p, v_cache)
        return (lambda x, *d: x.permute(*d))(o, 0, 2, 1, 3).reshape(B, Sq, H * Dh) @ wo

    def _B_ref(x, w_gate, w_up, w_down):
        return _gelu(x @ w_gate) * (x @ w_up) @ w_down
    x = A_x
    mod = (_silu(c) @ w_mod).reshape(c.shape[0], 6, 1, -1)
    sa, ca, ga, sb, cb, gb = (mod[:, 0].clone(), mod[:, 1].clone(), mod[:, 2].clone(), mod[:, 3].clone(), mod[:, 4].clone(), mod[:, 5].clone())
    h = _layernorm(x, axis=-1) * (1 + ca) + sa
    x = x + ga * _A_ref(h, A_k_cache, A_v_cache, A_wq, A_wo)
    h = _layernorm(x, axis=-1) * (1 + cb) + sb
    x = x + gb * _B_ref(h, B_w_gate, B_w_up, B_w_down)
    return x
```

```asm
; @launch grid=(256,1,1) block=(1024,1,1) lds=160512
.amdgcn_target "amdgcn-amd-amdhsa--gfx950"
.text
.globl adaLN_cond__mha_block_cached__geglu_ffn__decode_kernel
.p2align 8
.type adaLN_cond__mha_block_cached__geglu_ffn__decode_kernel,@function
adaLN_cond__mha_block_cached__geglu_ffn__decode_kernel:
    s_cmp_ge_u32 s2, 256
    s_cbranch_scc1 L_exit
    s_load_dwordx16 s[16:31], s[0:1], 0
    s_load_dwordx8 s[32:39], s[0:1], 64
    s_load_dwordx4 s[40:43], s[0:1], 96
    s_cmp_ge_u32 s2, 32
    s_cbranch_scc1 L_stream
    v_lshrrev_b32 v1, 6, v0
    s_nop 0
    v_readfirstlane_b32 s60, v1
    v_and_b32 v1, 63, v0
    v_mov_b32 v31, 0
    s_waitcnt lgkmcnt(0)
    s_mov_b32 s44, s34
    s_and_b32 s45, s35, 0xffff
    s_mov_b32 s46, 1792
    s_mov_b32 s47, 0x00020000
    s_mov_b32 s48, s36
    s_and_b32 s49, s37, 0xffff
    s_mov_b32 s50, 2408448
    s_mov_b32 s51, 0x00020000
    s_mov_b32 s52, s22
    s_and_b32 s53, s23, 0xffff
    s_mov_b32 s54, 3670016
    s_mov_b32 s55, 0x00020000
    s_cmp_lg_u32 s60, 15
    s_cbranch_scc1 L_sv_nononce
    s_memrealtime s[62:63]
    s_waitcnt lgkmcnt(0)
    s_or_b32 s62, s62, 1
    v_mov_b32 v8, s62
    v_mov_b32 v9, s63
    v_mov_b32 v10, 0
    v_mov_b32 v11, 0
    s_mov_b64 s[64:65], exec
    s_mov_b64 exec, 1
    global_atomic_cmpswap_x2 v[12:13], v31, v[8:11], s[40:41] sc0 sc1
    s_mov_b64 exec, s[64:65]
L_sv_nononce:
    s_cmp_ge_u32 s60, 2
    s_cbranch_scc1 L_sv_nox
    s_mul_i32 s61, s60, 896
    v_lshl_add_u32 v2, v1, 1, s61
    global_load_ushort v60, v2, s[16:17] offset:0
    global_load_ushort v61, v2, s[16:17] offset:128
    global_load_ushort v62, v2, s[16:17] offset:256
    global_load_ushort v63, v2, s[16:17] offset:384
    global_load_ushort v64, v2, s[16:17] offset:512
    global_load_ushort v65, v2, s[16:17] offset:640
    global_load_ushort v66, v2, s[16:17] offset:768
L_sv_nox:
    v_lshlrev_b32 v2, 1, v0
    buffer_load_ushort v28, v2, s[44:47], 0 offen
    v_and_b32 v30, 7, v0
    v_lshrrev_b32 v6, 3, v0
    v_mul_u32_u24 v3, 5376, v6
    v_lshl_add_u32 v3, v30, 4, v3
    s_cmp_ge_u32 s2, 14
    s_cselect_b32 s56, 1, 0
    s_mul_i32 s57, s56, 14
    s_sub_u32 s57, s2, s57
    s_mul_i32 s58, s56, 1204224
    s_lshl_b32 s59, s57, 7
    s_add_u32 s58, s58, s59
    s_cmp_ge_u32 s2, 28
    s_cselect_b32 s58, 0x7f000000, s58
    s_add_u32 s59, s58, 688128
    v_mov_b32 v4, 0x7f000000
    v_cmp_gt_u32 vcc, 96, v6
    s_nop 1
    v_cndmask_b32 v4, v4, v3, vcc
    buffer_load_dwordx4 v[16:19], v3, s[48:51], s58 offen nt
    buffer_load_dwordx4 v[20:23], v4, s[48:51], s59 offen nt
    s_lshl_b32 s61, s2, 6
    v_mov_b32 v126, s61
    global_load_dword v127, v126, s[42:43] sc1
    v_cmp_le_u32 vcc, 448, v0
    s_nop 1
    v_cndmask_b32 v2, 0, 1, vcc
    v_mul_u32_u24 v3, 448, v2
    v_sub_u32 v3, v0, v3
    v_lshl_add_u32 v2, v3, 1, v2
    v_lshlrev_b32 v2, 2, v2
    v_lshlrev_b32 v3, 2, v0
    v_cmp_le_u32 vcc, 896, v0
    s_nop 1
    v_cndmask_b32 v2, v2, v3, vcc
    v_mov_b32 v5, 0
    s_cmp_ge_u32 s60, 14
    s_cbranch_scc1 L_sv_nocwait
    s_waitcnt vmcnt(3)
    v_lshlrev_b32 v5, 16, v28
L_sv_nocwait:
    v_mul_f32 v3, 0xbfb8aa3b, v5
    v_exp_f32 v3, v3
    s_nop 0
    v_add_f32 v3, 1.0, v3
    v_rcp_f32 v3, v3
    s_nop 0
    v_mul_f32 v5, v5, v3
    v_cvt_pk_bf16_f32 v3, v5, v5
    v_lshlrev_b32 v5, 16, v3
    ds_write_b32 v2, v5 offset:4096
    s_cmp_lt_u32 s60, 14
    s_cbranch_scc1 L_sv_nopad
    ds_write_b32 v2, v5 offset:0
L_sv_nopad:
    s_waitcnt lgkmcnt(0)
    s_barrier
    v_lshrrev_b32 v7, 4, v0
    v_lshlrev_b32 v3, 13, v7
    v_and_b32 v4, 15, v0
    v_lshl_add_u32 v3, v4, 4, v3
    s_lshl_b32 s61, s2, 8
    buffer_load_dwordx4 v[96:99], v3, s[52:55], s61 offen nt
    s_add_u32 s61, s61, 524288
    buffer_load_dwordx4 v[100:103], v3, s[52:55], s61 offen nt
    s_add_u32 s61, s61, 524288
    buffer_load_dwordx4 v[104:107], v3, s[52:55], s61 offen nt
    s_add_u32 s61, s61, 524288
    buffer_load_dwordx4 v[108:111], v3, s[52:55], s61 offen nt
    s_add_u32 s61, s61, 524288
    buffer_load_dwordx4 v[112:115], v3, s[52:55], s61 offen nt
    s_add_u32 s61, s61, 524288
    buffer_load_dwordx4 v[116:119], v3, s[52:55], s61 offen nt
    s_add_u32 s61, s61, 524288
    buffer_load_dwordx4 v[120:123], v3, s[52:55], s61 offen nt
    s_add_u32 s61, s61, 524288
    s_mul_i32 s61, s56, 1792
    v_lshl_add_u32 v4, v6, 3, s61
    ds_read_b64 v[24:25], v4 offset:4096
    ds_read_b64 v[26:27], v4 offset:5120
    v_mov_b32 v32, 0
    v_mov_b32 v33, 0
    v_mov_b32 v34, 0
    v_mov_b32 v35, 0
    v_mov_b32 v36, 0
    v_mov_b32 v37, 0
    v_mov_b32 v38, 0
    v_mov_b32 v39, 0
    v_mov_b32 v40, 0
    v_mov_b32 v41, 0
    v_mov_b32 v42, 0
    v_mov_b32 v43, 0
    v_mov_b32 v44, 0
    v_mov_b32 v45, 0
    v_mov_b32 v46, 0
    v_mov_b32 v47, 0
    s_waitcnt vmcnt(8) lgkmcnt(0)
    v_lshlrev_b32 v28, 16, v16
    v_and_b32 v29, 0xffff0000, v16
    v_pk_fma_f32 v[32:33], v[28:29], v[24:25], v[32:33] op_sel:[0,0,0] op_sel_hi:[1,0,1]
    v_pk_fma_f32 v[40:41], v[28:29], v[24:25], v[40:41] op_sel:[0,1,0] op_sel_hi:[1,1,1]
    v_lshlrev_b32 v28, 16, v17
    v_and_b32 v29, 0xffff0000, v17
    v_pk_fma_f32 v[34:35], v[28:29], v[24:25], v[34:35] op_sel:[0,0,0] op_sel_hi:[1,0,1]
    v_pk_fma_f32 v[42:43], v[28:29], v[24:25], v[42:43] op_sel:[0,1,0] op_sel_hi:[1,1,1]
    v_lshlrev_b32 v28, 16, v18
    v_and_b32 v29, 0xffff0000, v18
    v_pk_fma_f32 v[36:37], v[28:29], v[24:25], v[36:37] op_sel:[0,0,0] op_sel_hi:[1,0,1]
    v_pk_fma_f32 v[44:45], v[28:29], v[24:25], v[44:45] op_sel:[0,1,0] op_sel_hi:[1,1,1]
    v_lshlrev_b32 v28, 16, v19
    v_and_b32 v29, 0xffff0000, v19
    v_pk_fma_f32 v[38:39], v[28:29], v[24:25], v[38:39] op_sel:[0,0,0] op_sel_hi:[1,0,1]
    v_pk_fma_f32 v[46:47], v[28:29], v[24:25], v[46:47] op_sel:[0,1,0] op_sel_hi:[1,1,1]
    v_lshlrev_b32 v28, 16, v20
    v_and_b32 v29, 0xffff0000, v20
    v_pk_fma_f32 v[32:33], v[28:29], v[26:27], v[32:33] op_sel:[0,0,0] op_sel_hi:[1,0,1]
    v_pk_fma_f32 v[40:41], v[28:29], v[26:27], v[40:41] op_sel:[0,1,0] op_sel_hi:[1,1,1]
    v_lshlrev_b32 v28, 16, v21
    v_and_b32 v29, 0xffff0000, v21
    v_pk_fma_f32 v[34:35], v[28:29], v[26:27], v[34:35] op_sel:[0,0,0] op_sel_hi:[1,0,1]
    v_pk_fma_f32 v[42:43], v[28:29], v[26:27], v[42:43] op_sel:[0,1,0] op_sel_hi:[1,1,1]
    v_lshlrev_b32 v28, 16, v22
    v_and_b32 v29, 0xffff0000, v22
    v_pk_fma_f32 v[36:37], v[28:29], v[26:27], v[36:37] op_sel:[0,0,0] op_sel_hi:[1,0,1]
    v_pk_fma_f32 v[44:45], v[28:29], v[26:27], v[44:45] op_sel:[0,1,0] op_sel_hi:[1,1,1]
    v_lshlrev_b32 v28, 16, v23
    v_and_b32 v29, 0xffff0000, v23
    v_pk_fma_f32 v[38:39], v[28:29], v[26:27], v[38:39] op_sel:[0,0,0] op_sel_hi:[1,0,1]
    v_pk_fma_f32 v[46:47], v[28:29], v[26:27], v[46:47] op_sel:[0,1,0] op_sel_hi:[1,1,1]
    s_nop 1
    v_add_f32_dpp v32, v32, v32 row_ror:8 row_mask:0xf bank_mask:0xf
    v_add_f32_dpp v33, v33, v33 row_ror:8 row_mask:0xf bank_mask:0xf
    v_add_f32_dpp v34, v34, v34 row_ror:8 row_mask:0xf bank_mask:0xf
    v_add_f32_dpp v35, v35, v35 row_ror:8 row_mask:0xf bank_mask:0xf
    v_add_f32_dpp v36, v36, v36 row_ror:8 row_mask:0xf bank_mask:0xf
    v_add_f32_dpp v37, v37, v37 row_ror:8 row_mask:0xf bank_mask:0xf
    v_add_f32_dpp v38, v38, v38 row_ror:8 row_mask:0xf bank_mask:0xf
    v_add_f32_dpp v39, v39, v39 row_ror:8 row_mask:0xf bank_mask:0xf
    v_add_f32_dpp v40, v40, v40 row_ror:8 row_mask:0xf bank_mask:0xf
    v_add_f32_dpp v41, v41, v41 row_ror:8 row_mask:0xf bank_mask:0xf
    v_add_f32_dpp v42, v42, v42 row_ror:8 row_mask:0xf bank_mask:0xf
    v_add_f32_dpp v43, v43, v43 row_ror:8 row_mask:0xf bank_mask:0xf
    v_add_f32_dpp v44, v44, v44 row_ror:8 row_mask:0xf bank_mask:0xf
    v_add_f32_dpp v45, v45, v45 row_ror:8 row_mask:0xf bank_mask:0xf
    v_add_f32_dpp v46, v46, v46 row_ror:8 row_mask:0xf bank_mask:0xf
    v_add_f32_dpp v47, v47, v47 row_ror:8 row_mask:0xf bank_mask:0xf
    s_nop 1
    v_permlane32_swap_b32 v32, v40
    v_permlane32_swap_b32 v33, v41
    v_permlane32_swap_b32 v34, v42
    v_permlane32_swap_b32 v35, v43
    v_permlane32_swap_b32 v36, v44
    v_permlane32_swap_b32 v37, v45
    v_permlane32_swap_b32 v38, v46
    v_permlane32_swap_b32 v39, v47
    v_add_f32 v32, v32, v40
    v_add_f32 v33, v33, v41
    v_add_f32 v34, v34, v42
    v_add_f32 v35, v35, v43
    v_add_f32 v36, v36, v44
    v_add_f32 v37, v37, v45
    v_add_f32 v38, v38, v46
    v_add_f32 v39, v39, v47
    s_nop 1
    v_permlane16_swap_b32 v32, v36
    v_permlane16_swap_b32 v33, v37
    v_permlane16_swap_b32 v34, v38
    v_permlane16_swap_b32 v35, v39
    v_add_f32 v32, v32, v36
    v_add_f32 v33, v33, v37
    v_add_f32 v34, v34, v38
    v_add_f32 v35, v35, v39
    v_lshrrev_b32 v4, 6, v0
    v_lshlrev_b32 v4, 9, v4
    v_and_b32 v5, 7, v0
    v_lshl_add_u32 v4, v5, 6, v4
    v_bfe_u32 v5, v0, 4, 2
    v_lshl_add_u32 v4, v5, 4, v4
    ds_write_b128 v4, v[32:35] offset:15616
    s_cmp_lg_u32 s60, 15
    s_cbranch_scc1 L_sv_nononce2
    v_cmp_eq_u32 vcc, 0, v12
    s_nop 1
    v_cndmask_b32 v12, v12, v8, vcc
    v_cndmask_b32 v13, v13, v9, vcc
    s_mov_b64 s[64:65], exec
    s_mov_b64 exec, 1
    ds_write_b64 v31, v[12:13] offset:8192
    s_mov_b64 exec, s[64:65]
L_sv_nononce2:
    s_cmp_ge_u32 s60, 2
    s_cbranch_scc1 L_sv_noy
    v_lshlrev_b32 v60, 16, v60
    v_lshlrev_b32 v61, 16, v61
    v_lshlrev_b32 v62, 16, v62
    v_lshlrev_b32 v63, 16, v63
    v_lshlrev_b32 v64, 16, v64
    v_lshlrev_b32 v65, 16, v65
    v_lshlrev_b32 v66, 16, v66
    s_mul_i32 s61, s60, 1792
    v_lshl_add_u32 v4, v1, 2, s61
    ds_write_b32 v4, v60 offset:8448
    ds_write_b32 v4, v61 offset:8704
    ds_write_b32 v4, v62 offset:8960
    ds_write_b32 v4, v63 offset:9216
    ds_write_b32 v4, v64 offset:9472
    ds_write_b32 v4, v65 offset:9728
    ds_write_b32 v4, v66 offset:9984
    v_add_f32 v8, v60, v61
    v_add_f32 v8, v8, v62
    v_add_f32 v8, v8, v63
    v_add_f32 v8, v8, v64
    v_add_f32 v8, v8, v65
    v_add_f32 v8, v8, v66
    s_nop 1
    v_add_f32_dpp v8, v8, v8 quad_perm:[1,0,3,2] row_mask:0xf bank_mask:0xf
    s_nop 1
    v_add_f32_dpp v8, v8, v8 quad_perm:[2,3,0,1] row_mask:0xf bank_mask:0xf
    s_nop 1
    v_add_f32_dpp v8, v8, v8 row_half_mirror row_mask:0xf bank_mask:0xf
    s_nop 1
    v_add_f32_dpp v8, v8, v8 row_mirror row_mask:0xf bank_mask:0xf
    v_mov_b32 v9, v8
    s_nop 1
    v_permlane16_swap_b32 v8, v9
    v_add_f32 v8, v8, v9
    v_mov_b32 v9, v8
    s_nop 1
    v_permlane32_swap_b32 v8, v9
    v_add_f32 v8, v8, v9
    v_mul_f32 v8, 0x3b124925, v8
    v_sub_f32 v10, v60, v8
    v_mul_f32 v11, v10, v10
    v_sub_f32 v10, v61, v8
    v_fmac_f32 v11, v10, v10
    v_sub_f32 v10, v62, v8
    v_fmac_f32 v11, v10, v10
    v_sub_f32 v10, v63, v8
    v_fmac_f32 v11, v10, v10
    v_sub_f32 v10, v64, v8
    v_fmac_f32 v11, v10, v10
    v_sub_f32 v10, v65, v8
    v_fmac_f32 v11, v10, v10
    v_sub_f32 v10, v66, v8
    v_fmac_f32 v11, v10, v10
    s_nop 1
    v_add_f32_dpp v11, v11, v11 quad_perm:[1,0,3,2] row_mask:0xf bank_mask:0xf
    s_nop 1
    v_add_f32_dpp v11, v11, v11 quad_perm:[2,3,0,1] row_mask:0xf bank_mask:0xf
    s_nop 1
    v_add_f32_dpp v11, v11, v11 row_half_mirror row_mask:0xf bank_mask:0xf
    s_nop 1
    v_add_f32_dpp v11, v11, v11 row_mirror row_mask:0xf bank_mask:0xf
    v_mov_b32 v9, v11
    s_nop 1
    v_permlane16_swap_b32 v11, v9
    v_add_f32 v11, v11, v9
    v_mov_b32 v9, v11
    s_nop 1
    v_permlane32_swap_b32 v11, v9
    v_add_f32 v11, v11, v9
    v_mul_f32 v11, 0x3b124925, v11
    v_cvt_pk_bf16_f32 v9, v8, v8
    v_lshlrev_b32 v8, 16, v9
    v_cvt_pk_bf16_f32 v9, v11, v11
    v_lshlrev_b32 v11, 16, v9
    v_add_f32 v11, 0x3727c5ac, v11
    v_cvt_pk_bf16_f32 v9, v11, v11
    v_lshlrev_b32 v11, 16, v9
    v_sqrt_f32 v11, v11
    s_nop 0
    v_cvt_pk_bf16_f32 v9, v11, v11
    v_lshlrev_b32 v11, 16, v9
    v_rcp_f32 v12, v11
    s_nop 0
    v_lshlrev_b32 v4, 3, v1
    s_lshl_b32 s61, s60, 2
    v_add_u32 v4, s61, v4
    v_sub_f32 v16, v60, v8
    v_cvt_pk_bf16_f32 v17, v16, v16
    v_lshlrev_b32 v16, 16, v17
    v_mul_f32 v14, v16, v12
    v_fma_f32 v17, -v14, v11, v16
    v_fmac_f32 v14, v17, v12
    v_cvt_pk_bf16_f32 v17, v14, v14
    v_lshlrev_b32 v14, 16, v17
    ds_write_b32 v4, v14 offset:12032
    v_sub_f32 v16, v61, v8
    v_cvt_pk_bf16_f32 v17, v16, v16
    v_lshlrev_b32 v16, 16, v17
    v_mul_f32 v14, v16, v12
    v_fma_f32 v17, -v14, v11, v16
    v_fmac_f32 v14, v17, v12
    v_cvt_pk_bf16_f32 v17, v14, v14
    v_lshlrev_b32 v14, 16, v17
    ds_write_b32 v4, v14 offset:12544
    v_sub_f32 v16, v62, v8
    v_cvt_pk_bf16_f32 v17, v16, v16
    v_lshlrev_b32 v16, 16, v17
    v_mul_f32 v14, v16, v12
    v_fma_f32 v17, -v14, v11, v16
    v_fmac_f32 v14, v17, v12
    v_cvt_pk_bf16_f32 v17, v14, v14
    v_lshlrev_b32 v14, 16, v17
    ds_write_b32 v4, v14 offset:13056
    v_sub_f32 v16, v63, v8
    v_cvt_pk_bf16_f32 v17, v16, v16
    v_lshlrev_b32 v16, 16, v17
    v_mul_f32 v14, v16, v12
    v_fma_f32 v17, -v14, v11, v16
    v_fmac_f32 v14, v17, v12
    v_cvt_pk_bf16_f32 v17, v14, v14
    v_lshlrev_b32 v14, 16, v17
    ds_write_b32 v4, v14 offset:13568
    v_sub_f32 v16, v64, v8
    v_cvt_pk_bf16_f32 v17, v16, v16
    v_lshlrev_b32 v16, 16, v17
    v_mul_f32 v14, v16, v12
    v_fma_f32 v17, -v14, v11, v16
    v_fmac_f32 v14, v17, v12
    v_cvt_pk_bf16_f32 v17, v14, v14
    v_lshlrev_b32 v14, 16, v17
    ds_write_b32 v4, v14 offset:14080
    v_sub_f32 v16, v65, v8
    v_cvt_pk_bf16_f32 v17, v16, v16
    v_lshlrev_b32 v16, 16, v17
    v_mul_f32 v14, v16, v12
    v_fma_f32 v17, -v14, v11, v16
    v_fmac_f32 v14, v17, v12
    v_cvt_pk_bf16_f32 v17, v14, v14
    v_lshlrev_b32 v14, 16, v17
    ds_write_b32 v4, v14 offset:14592
    v_sub_f32 v16, v66, v8
    v_cvt_pk_bf16_f32 v17, v16, v16
    v_lshlrev_b32 v16, 16, v17
    v_mul_f32 v14, v16, v12
    v_fma_f32 v17, -v14, v11, v16
    v_fmac_f32 v14, v17, v12
    v_cvt_pk_bf16_f32 v17, v14, v14
    v_lshlrev_b32 v14, 16, v17
    ds_write_b32 v4, v14 offset:15104
L_sv_noy:
    s_waitcnt lgkmcnt(0)
    s_barrier
    ds_read_b64 v[2:3], v31 offset:8192
    s_waitcnt lgkmcnt(0)
    v_readfirstlane_b32 s80, v2
    v_readfirstlane_b32 s81, v3
    s_cmp_ge_u32 s2, 28
    s_cbranch_scc1 L_sv_modc_done
    v_cmp_gt_u32 vcc, 64, v0
    s_and_saveexec_b64 s[64:65], vcc
    s_cbranch_execz L_sv_modc_end
    v_lshrrev_b32 v2, 3, v0
    v_lshlrev_b32 v2, 4, v2
    v_and_b32 v3, 7, v0
    v_add_u32 v2, v2, v3
    v_lshlrev_b32 v2, 2, v2
    ds_read_b32 v32, v2 offset:15616
    ds_read_b32 v48, v2 offset:15648
    ds_read_b32 v33, v2 offset:16128
    ds_read_b32 v49, v2 offset:16160
    ds_read_b32 v34, v2 offset:16640
    ds_read_b32 v50, v2 offset:16672
    ds_read_b32 v35, v2 offset:17152
    ds_read_b32 v51, v2 offset:17184
    ds_read_b32 v36, v2 offset:17664
    ds_read_b32 v52, v2 offset:17696
    ds_read_b32 v37, v2 offset:18176
    ds_read_b32 v53, v2 offset:18208
    ds_read_b32 v38, v2 offset:18688
    ds_read_b32 v54, v2 offset:18720
    ds_read_b32 v39, v2 offset:19200
    ds_read_b32 v55, v2 offset:19232
    ds_read_b32 v40, v2 offset:19712
    ds_read_b32 v56, v2 offset:19744
    ds_read_b32 v41, v2 offset:20224
    ds_read_b32 v57, v2 offset:20256
    ds_read_b32 v42, v2 offset:20736
    ds_read_b32 v58, v2 offset:20768
    ds_read_b32 v43, v2 offset:21248
    ds_read_b32 v59, v2 offset:21280
    ds_read_b32 v44, v2 offset:21760
    ds_read_b32 v60, v2 offset:21792
    ds_read_b32 v45, v2 offset:22272
    ds_read_b32 v61, v2 offset:22304
    ds_read_b32 v46, v2 offset:22784
    ds_read_b32 v62, v2 offset:22816
    ds_read_b32 v47, v2 offset:23296
    ds_read_b32 v63, v2 offset:23328
    s_waitcnt lgkmcnt(0)
    v_add_f32 v32, v32, v33
    v_add_f32 v48, v48, v49
    v_add_f32 v32, v32, v34
    v_add_f32 v48, v48, v50
    v_add_f32 v32, v32, v35
    v_add_f32 v48, v48, v51
    v_add_f32 v32, v32, v36
    v_add_f32 v48, v48, v52
    v_add_f32 v32, v32, v37
    v_add_f32 v48, v48, v53
    v_add_f32 v32, v32, v38
    v_add_f32 v48, v48, v54
    v_add_f32 v32, v32, v39
    v_add_f32 v48, v48, v55
    v_add_f32 v32, v32, v40
    v_add_f32 v48, v48, v56
    v_add_f32 v32, v32, v41
    v_add_f32 v48, v48, v57
    v_add_f32 v32, v32, v42
    v_add_f32 v48, v48, v58
    v_add_f32 v32, v32, v43
    v_add_f32 v48, v48, v59
    v_add_f32 v32, v32, v44
    v_add_f32 v48, v48, v60
    v_add_f32 v32, v32, v45
    v_add_f32 v48, v48, v61
    v_add_f32 v32, v32, v46
    v_add_f32 v48, v48, v62
    v_add_f32 v32, v32, v47
    v_add_f32 v48, v48, v63
    v_mov_b32 v33, v48
    v_mov_b32 v34, s80
    v_mov_b32 v35, s81
    s_mul_i32 s61, s56, 896
    s_lshl_b32 s62, s57, 6
    s_add_u32 s61, s61, s62
    v_add_u32 v3, s61, v0
    v_lshlrev_b32 v3, 4, v3
    global_store_dwordx4 v3, v[32:35], s[42:43] offset:0 sc1
L_sv_modc_end:
    s_mov_b64 exec, s[64:65]
L_sv_modc_done:
    s_mov_b32 s72, s24
    s_and_b32 s73, s25, 0xffff
    s_mov_b32 s74, 3670016
    s_mov_b32 s75, 0x00020000
    s_cmp_lt_u32 s60, 8
    s_cbranch_scc1 L_sv_nowodma
    s_sub_u32 s61, s60, 8
    s_mul_i32 s62, s61, 896
    v_add_u32 v2, s62, v1
    s_mov_b32 s63, 0x4924925
    s_mov_b32 s63, 0x924924A
    v_mul_hi_u32 v3, v2, s63
    v_mul_u32_u24 v4, 28, v3
    v_sub_u32 v4, v2, v4
    s_lshr_b32 s62, s2, 1
    s_mul_i32 s62, s62, 229376
    s_and_b32 s63, s2, 1
    s_mul_i32 s63, s63, 448
    s_add_u32 s62, s62, s63
    s_mul_i32 s61, s61, 14336
    s_add_u32 s61, s61, 45824
    v_mul_u32_u24 v5, 896, v3
    v_lshl_add_u32 v5, v4, 4, v5
    s_mov_b32 m0, s61
    s_add_u32 s61, s61, 1024
    buffer_load_dwordx4 v5, s[72:75], s62 offen nt lds
    v_add_u32 v3, 2, v3
    v_add_u32 v4, 8, v4
    v_cmp_le_u32 vcc, 28, v4
    v_subrev_u32 v6, 28, v4
    s_nop 0
    v_addc_co_u32 v3, vcc, 0, v3, vcc
    v_cmp_le_u32 vcc, 28, v4
    s_nop 1
    v_cndmask_b32 v4, v4, v6, vcc
    v_mul_u32_u24 v5, 896, v3
    v_lshl_add_u32 v5, v4, 4, v5
    s_mov_b32 m0, s61
    s_add_u32 s61, s61, 1024
    buffer_load_dwordx4 v5, s[72:75], s62 offen nt lds
    v_add_u32 v3, 2, v3
    v_add_u32 v4, 8, v4
    v_cmp_le_u32 vcc, 28, v4
    v_subrev_u32 v6, 28, v4
    s_nop 0
    v_addc_co_u32 v3, vcc, 0, v3, vcc
    v_cmp_le_u32 vcc, 28, v4
    s_nop 1
    v_cndmask_b32 v4, v4, v6, vcc
    v_mul_u32_u24 v5, 896, v3
    v_lshl_add_u32 v5, v4, 4, v5
    s_mov_b32 m0, s61
    s_add_u32 s61, s61, 1024
    buffer_load_dwordx4 v5, s[72:75], s62 offen nt lds
    v_add_u32 v3, 2, v3
    v_add_u32 v4, 8, v4
    v_cmp_le_u32 vcc, 28, v4
    v_subrev_u32 v6, 28, v4
    s_nop 0
    v_addc_co_u32 v3, vcc, 0, v3, vcc
    v_cmp_le_u32 vcc, 28, v4
    s_nop 1
    v_cndmask_b32 v4, v4, v6, vcc
    v_mul_u32_u24 v5, 896, v3
    v_lshl_add_u32 v5, v4, 4, v5
    s_mov_b32 m0, s61
    s_add_u32 s61, s61, 1024
    buffer_load_dwordx4 v5, s[72:75], s62 offen nt lds
    v_add_u32 v3, 2, v3
    v_add_u32 v4, 8, v4
    v_cmp_le_u32 vcc, 28, v4
    v_subrev_u32 v6, 28, v4
    s_nop 0
    v_addc_co_u32 v3, vcc, 0, v3, vcc
    v_cmp_le_u32 vcc, 28, v4
    s_nop 1
    v_cndmask_b32 v4, v4, v6, vcc
    v_mul_u32_u24 v5, 896, v3
    v_lshl_add_u32 v5, v4, 4, v5
    s_mov_b32 m0, s61
    s_add_u32 s61, s61, 1024
    buffer_load_dwordx4 v5, s[72:75], s62 offen nt lds
    v_add_u32 v3, 2, v3
    v_add_u32 v4, 8, v4
    v_cmp_le_u32 vcc, 28, v4
    v_subrev_u32 v6, 28, v4
    s_nop 0
    v_addc_co_u32 v3, vcc, 0, v3, vcc
    v_cmp_le_u32 vcc, 28, v4
    s_nop 1
    v_cndmask_b32 v4, v4, v6, vcc
    v_mul_u32_u24 v5, 896, v3
    v_lshl_add_u32 v5, v4, 4, v5
    s_mov_b32 m0, s61
    s_add_u32 s61, s61, 1024
    buffer_load_dwordx4 v5, s[72:75], s62 offen nt lds
    v_add_u32 v3, 2, v3
    v_add_u32 v4, 8, v4
    v_cmp_le_u32 vcc, 28, v4
    v_subrev_u32 v6, 28, v4
    s_nop 0
    v_addc_co_u32 v3, vcc, 0, v3, vcc
    v_cmp_le_u32 vcc, 28, v4
    s_nop 1
    v_cndmask_b32 v4, v4, v6, vcc
    v_mul_u32_u24 v5, 896, v3
    v_lshl_add_u32 v5, v4, 4, v5
    s_mov_b32 m0, s61
    s_add_u32 s61, s61, 1024
    buffer_load_dwordx4 v5, s[72:75], s62 offen nt lds
    v_add_u32 v3, 2, v3
    v_add_u32 v4, 8, v4
    v_cmp_le_u32 vcc, 28, v4
    v_subrev_u32 v6, 28, v4
    s_nop 0
    v_addc_co_u32 v3, vcc, 0, v3, vcc
    v_cmp_le_u32 vcc, 28, v4
    s_nop 1
    v_cndmask_b32 v4, v4, v6, vcc
    v_mul_u32_u24 v5, 896, v3
    v_lshl_add_u32 v5, v4, 4, v5
    s_mov_b32 m0, s61
    s_add_u32 s61, s61, 1024
    buffer_load_dwordx4 v5, s[72:75], s62 offen nt lds
    v_add_u32 v3, 2, v3
    v_add_u32 v4, 8, v4
    v_cmp_le_u32 vcc, 28, v4
    v_subrev_u32 v6, 28, v4
    s_nop 0
    v_addc_co_u32 v3, vcc, 0, v3, vcc
    v_cmp_le_u32 vcc, 28, v4
    s_nop 1
    v_cndmask_b32 v4, v4, v6, vcc
    v_mul_u32_u24 v5, 896, v3
    v_lshl_add_u32 v5, v4, 4, v5
    s_mov_b32 m0, s61
    s_add_u32 s61, s61, 1024
    buffer_load_dwordx4 v5, s[72:75], s62 offen nt lds
    v_add_u32 v3, 2, v3
    v_add_u32 v4, 8, v4
    v_cmp_le_u32 vcc, 28, v4
    v_subrev_u32 v6, 28, v4
    s_nop 0
    v_addc_co_u32 v3, vcc, 0, v3, vcc
    v_cmp_le_u32 vcc, 28, v4
    s_nop 1
    v_cndmask_b32 v4, v4, v6, vcc
    v_mul_u32_u24 v5, 896, v3
    v_lshl_add_u32 v5, v4, 4, v5
    s_mov_b32 m0, s61
    s_add_u32 s61, s61, 1024
    buffer_load_dwordx4 v5, s[72:75], s62 offen nt lds
    v_add_u32 v3, 2, v3
    v_add_u32 v4, 8, v4
    v_cmp_le_u32 vcc, 28, v4
    v_subrev_u32 v6, 28, v4
    s_nop 0
    v_addc_co_u32 v3, vcc, 0, v3, vcc
    v_cmp_le_u32 vcc, 28, v4
    s_nop 1
    v_cndmask_b32 v4, v4, v6, vcc
    v_mul_u32_u24 v5, 896, v3
    v_lshl_add_u32 v5, v4, 4, v5
    s_mov_b32 m0, s61
    s_add_u32 s61, s61, 1024
    buffer_load_dwordx4 v5, s[72:75], s62 offen nt lds
    v_add_u32 v3, 2, v3
    v_add_u32 v4, 8, v4
    v_cmp_le_u32 vcc, 28, v4
    v_subrev_u32 v6, 28, v4
    s_nop 0
    v_addc_co_u32 v3, vcc, 0, v3, vcc
    v_cmp_le_u32 vcc, 28, v4
    s_nop 1
    v_cndmask_b32 v4, v4, v6, vcc
    v_mul_u32_u24 v5, 896, v3
    v_lshl_add_u32 v5, v4, 4, v5
    s_mov_b32 m0, s61
    s_add_u32 s61, s61, 1024
    buffer_load_dwordx4 v5, s[72:75], s62 offen nt lds
    v_add_u32 v3, 2, v3
    v_add_u32 v4, 8, v4
    v_cmp_le_u32 vcc, 28, v4
    v_subrev_u32 v6, 28, v4
    s_nop 0
    v_addc_co_u32 v3, vcc, 0, v3, vcc
    v_cmp_le_u32 vcc, 28, v4
    s_nop 1
    v_cndmask_b32 v4, v4, v6, vcc
    v_mul_u32_u24 v5, 896, v3
    v_lshl_add_u32 v5, v4, 4, v5
    s_mov_b32 m0, s61
    s_add_u32 s61, s61, 1024
    buffer_load_dwordx4 v5, s[72:75], s62 offen nt lds
    v_add_u32 v3, 2, v3
    v_add_u32 v4, 8, v4
    v_cmp_le_u32 vcc, 28, v4
    v_subrev_u32 v6, 28, v4
    s_nop 0
    v_addc_co_u32 v3, vcc, 0, v3, vcc
    v_cmp_le_u32 vcc, 28, v4
    s_nop 1
    v_cndmask_b32 v4, v4, v6, vcc
    v_mul_u32_u24 v5, 896, v3
    v_lshl_add_u32 v5, v4, 4, v5
    s_mov_b32 m0, s61
    s_add_u32 s61, s61, 1024
    buffer_load_dwordx4 v5, s[72:75], s62 offen nt lds
L_sv_nowodma:
    v_cmp_gt_u32 vcc, 448, v0
    s_and_saveexec_b64 s[64:65], vcc
    s_cbranch_execz L_sv_h_end
    v_lshlrev_b32 v4, 4, v0
    v_add_u32 v5, 7168, v4
    v_add_u32 v6, 14336, v4
    v_add_u32 v29, 21504, v4
    v_lshlrev_b32 v30, 3, v0
    ds_read_b64 v[24:25], v30 offset:12032
    s_mov_b32 s79, 20000
L_poll_modc:
    global_load_dwordx4 v[8:11], v4, s[42:43] offset:0 sc1
    global_load_dwordx4 v[12:15], v5, s[42:43] offset:0 sc1
    global_load_dwordx4 v[16:19], v6, s[42:43] offset:0 sc1
    global_load_dwordx4 v[20:23], v29, s[42:43] offset:0 sc1
    s_waitcnt vmcnt(0)
    v_xor_b32 v2, s80, v10
    v_xor_b32 v3, s81, v11
    v_or_b32 v2, v2, v3
    v_xor_b32 v3, s80, v14
    v_or_b32 v2, v2, v3
    v_xor_b32 v3, s81, v15
    v_or_b32 v2, v2, v3
    v_xor_b32 v3, s80, v18
    v_or_b32 v2, v2, v3
    v_xor_b32 v3, s81, v19
    v_or_b32 v2, v2, v3
    v_xor_b32 v3, s80, v22
    v_or_b32 v2, v2, v3
    v_xor_b32 v3, s81, v23
    v_or_b32 v2, v2, v3
    v_cmp_ne_u32 vcc, 0, v2
    s_cbranch_vccz L_pollok_modc
    s_sleep 1
    s_sub_u32 s79, s79, 1
    s_cmp_lg_u32 s79, 0
    s_cbranch_scc1 L_poll_modc
L_pollok_modc:
    s_waitcnt lgkmcnt(0)
    v_add_f32 v8, v8, v16
    v_cvt_pk_bf16_f32 v2, v8, v8
    v_lshlrev_b32 v8, 16, v2
    v_add_f32 v12, v12, v20
    v_cvt_pk_bf16_f32 v2, v12, v12
    v_lshlrev_b32 v12, 16, v2
    v_add_f32 v12, 1.0, v12
    v_cvt_pk_bf16_f32 v2, v12, v12
    v_lshlrev_b32 v12, 16, v2
    v_mul_f32 v12, v24, v12
    v_cvt_pk_bf16_f32 v2, v12, v12
    v_lshlrev_b32 v12, 16, v2
    v_add_f32 v12, v12, v8
    v_cvt_pk_bf16_f32 v2, v12, v12
    v_lshlrev_b32 v12, 16, v2
    v_add_f32 v9, v9, v17
    v_cvt_pk_bf16_f32 v2, v9, v9
    v_lshlrev_b32 v9, 16, v2
    v_add_f32 v13, v13, v21
    v_cvt_pk_bf16_f32 v2, v13, v13
    v_lshlrev_b32 v13, 16, v2
    v_add_f32 v13, 1.0, v13
    v_cvt_pk_bf16_f32 v2, v13, v13
    v_lshlrev_b32 v13, 16, v2
    v_mul_f32 v13, v25, v13
    v_cvt_pk_bf16_f32 v2, v13, v13
    v_lshlrev_b32 v13, 16, v2
    v_add_f32 v13, v13, v9
    v_cvt_pk_bf16_f32 v2, v13, v13
    v_lshlrev_b32 v13, 16, v2
    ds_write_b64 v30, v[12:13] offset:0
L_sv_h_end:
    s_mov_b64 exec, s[64:65]
    s_waitcnt lgkmcnt(0)
    s_barrier
    v_lshlrev_b32 v4, 3, v7
    ds_read_b64 v[8:9], v4 offset:0
    ds_read_b64 v[10:11], v4 offset:512
    ds_read_b64 v[12:13], v4 offset:1024
    ds_read_b64 v[14:15], v4 offset:1536
    ds_read_b64 v[16:17], v4 offset:2048
    ds_read_b64 v[18:19], v4 offset:2560
    ds_read_b64 v[20:21], v4 offset:3072
    v_mov_b32 v32, 0
    v_mov_b32 v33, 0
    v_mov_b32 v34, 0
    v_mov_b32 v35, 0
    v_mov_b32 v36, 0
    v_mov_b32 v37, 0
    v_mov_b32 v38, 0
    v_mov_b32 v39, 0
    v_mov_b32 v40, 0
    v_mov_b32 v41, 0
    v_mov_b32 v42, 0
    v_mov_b32 v43, 0
    v_mov_b32 v44, 0
    v_mov_b32 v45, 0
    v_mov_b32 v46, 0
    v_mov_b32 v47, 0
    s_cmp_lt_u32 s60, 8
    s_cbranch_scc1 L_sv_q8a
    s_waitcnt vmcnt(14) lgkmcnt(0)
    s_branch L_sv_q8b
L_sv_q8a:
    s_waitcnt vmcnt(0) lgkmcnt(0)
L_sv_q8b:
    v_lshlrev_b32 v28, 16, v96
    v_and_b32 v29, 0xffff0000, v96
    v_pk_fma_f32 v[32:33], v[28:29], v[8:9], v[32:33] op_sel:[0,0,0] op_sel_hi:[1,0,1]
    v_pk_fma_f32 v[40:41], v[28:29], v[8:9], v[40:41] op_sel:[0,1,0] op_sel_hi:[1,1,1]
    v_lshlrev_b32 v28, 16, v97
    v_and_b32 v29, 0xffff0000, v97
    v_pk_fma_f32 v[34:35], v[28:29], v[8:9], v[34:35] op_sel:[0,0,0] op_sel_hi:[1,0,1]
    v_pk_fma_f32 v[42:43], v[28:29], v[8:9], v[42:43] op_sel:[0,1,0] op_sel_hi:[1,1,1]
    v_lshlrev_b32 v28, 16, v98
    v_and_b32 v29, 0xffff0000, v98
    v_pk_fma_f32 v[36:37], v[28:29], v[8:9], v[36:37] op_sel:[0,0,0] op_sel_hi:[1,0,1]
    v_pk_fma_f32 v[44:45], v[28:29], v[8:9], v[44:45] op_sel:[0,1,0] op_sel_hi:[1,1,1]
    v_lshlrev_b32 v28, 16, v99
    v_and_b32 v29, 0xffff0000, v99
    v_pk_fma_f32 v[38:39], v[28:29], v[8:9], v[38:39] op_sel:[0,0,0] op_sel_hi:[1,0,1]
    v_pk_fma_f32 v[46:47], v[28:29], v[8:9], v[46:47] op_sel:[0,1,0] op_sel_hi:[1,1,1]
    v_lshlrev_b32 v28, 16, v100
    v_and_b32 v29, 0xffff0000, v100
    v_pk_fma_f32 v[32:33], v[28:29], v[10:11], v[32:33] op_sel:[0,0,0] op_sel_hi:[1,0,1]
    v_pk_fma_f32 v[40:41], v[28:29], v[10:11], v[40:41] op_sel:[0,1,0] op_sel_hi:[1,1,1]
    v_lshlrev_b32 v28, 16, v101
    v_and_b32 v29, 0xffff0000, v101
    v_pk_fma_f32 v[34:35], v[28:29], v[10:11], v[34:35] op_sel:[0,0,0] op_sel_hi:[1,0,1]
    v_pk_fma_f32 v[42:43], v[28:29], v[10:11], v[42:43] op_sel:[0,1,0] op_sel_hi:[1,1,1]
    v_lshlrev_b32 v28, 16, v102
    v_and_b32 v29, 0xffff0000, v102
    v_pk_fma_f32 v[36:37], v[28:29], v[10:11], v[36:37] op_sel:[0,0,0] op_sel_hi:[1,0,1]
    v_pk_fma_f32 v[44:45], v[28:29], v[10:11], v[44:45] op_sel:[0,1,0] op_sel_hi:[1,1,1]
    v_lshlrev_b32 v28, 16, v103
    v_and_b32 v29, 0xffff0000, v103
    v_pk_fma_f32 v[38:39], v[28:29], v[10:11], v[38:39] op_sel:[0,0,0] op_sel_hi:[1,0,1]
    v_pk_fma_f32 v[46:47], v[28:29], v[10:11], v[46:47] op_sel:[0,1,0] op_sel_hi:[1,1,1]
    v_lshlrev_b32 v28, 16, v104
    v_and_b32 v29, 0xffff0000, v104
    v_pk_fma_f32 v[32:33], v[28:29], v[12:13], v[32:33] op_sel:[0,0,0] op_sel_hi:[1,0,1]
    v_pk_fma_f32 v[40:41], v[28:29], v[12:13], v[40:41] op_sel:[0,1,0] op_sel_hi:[1,1,1]
    v_lshlrev_b32 v28, 16, v105
    v_and_b32 v29, 0xffff0000, v105
    v_pk_fma_f32 v[34:35], v[28:29], v[12:13], v[34:35] op_sel:[0,0,0] op_sel_hi:[1,0,1]
    v_pk_fma_f32 v[42:43], v[28:29], v[12:13], v[42:43] op_sel:[0,1,0] op_sel_hi:[1,1,1]
    v_lshlrev_b32 v28, 16, v106
    v_and_b32 v29, 0xffff0000, v106
    v_pk_fma_f32 v[36:37], v[28:29], v[12:13], v[36:37] op_sel:[0,0,0] op_sel_hi:[1,0,1]
    v_pk_fma_f32 v[44:45], v[28:29], v[12:13], v[44:45] op_sel:[0,1,0] op_sel_hi:[1,1,1]
    v_lshlrev_b32 v28, 16, v107
    v_and_b32 v29, 0xffff0000, v107
    v_pk_fma_f32 v[38:39], v[28:29], v[12:13], v[38:39] op_sel:[0,0,0] op_sel_hi:[1,0,1]
    v_pk_fma_f32 v[46:47], v[28:29], v[12:13], v[46:47] op_sel:[0,1,0] op_sel_hi:[1,1,1]
    v_lshlrev_b32 v28, 16, v108
    v_and_b32 v29, 0xffff0000, v108
    v_pk_fma_f32 v[32:33], v[28:29], v[14:15], v[32:33] op_sel:[0,0,0] op_sel_hi:[1,0,1]
    v_pk_fma_f32 v[40:41], v[28:29], v[14:15], v[40:41] op_sel:[0,1,0] op_sel_hi:[1,1,1]
    v_lshlrev_b32 v28, 16, v109
    v_and_b32 v29, 0xffff0000, v109
    v_pk_fma_f32 v[34:35], v[28:29], v[14:15], v[34:35] op_sel:[0,0,0] op_sel_hi:[1,0,1]
    v_pk_fma_f32 v[42:43], v[28:29], v[14:15], v[42:43] op_sel:[0,1,0] op_sel_hi:[1,1,1]
    v_lshlrev_b32 v28, 16, v110
    v_and_b32 v29, 0xffff0000, v110
    v_pk_fma_f32 v[36:37], v[28:29], v[14:15], v[36:37] op_sel:[0,0,0] op_sel_hi:[1,0,1]
    v_pk_fma_f32 v[44:45], v[28:29], v[14:15], v[44:45] op_sel:[0,1,0] op_sel_hi:[1,1,1]
    v_lshlrev_b32 v28, 16, v111
    v_and_b32 v29, 0xffff0000, v111
    v_pk_fma_f32 v[38:39], v[28:29], v[14:15], v[38:39] op_sel:[0,0,0] op_sel_hi:[1,0,1]
    v_pk_fma_f32 v[46:47], v[28:29], v[14:15], v[46:47] op_sel:[0,1,0] op_sel_hi:[1,1,1]
    v_lshlrev_b32 v28, 16, v112
    v_and_b32 v29, 0xffff0000, v112
    v_pk_fma_f32 v[32:33], v[28:29], v[16:17], v[32:33] op_sel:[0,0,0] op_sel_hi:[1,0,1]
    v_pk_fma_f32 v[40:41], v[28:29], v[16:17], v[40:41] op_sel:[0,1,0] op_sel_hi:[1,1,1]
    v_lshlrev_b32 v28, 16, v113
    v_and_b32 v29, 0xffff0000, v113
    v_pk_fma_f32 v[34:35], v[28:29], v[16:17], v[34:35] op_sel:[0,0,0] op_sel_hi:[1,0,1]
    v_pk_fma_f32 v[42:43], v[28:29], v[16:17], v[42:43] op_sel:[0,1,0] op_sel_hi:[1,1,1]
    v_lshlrev_b32 v28, 16, v114
    v_and_b32 v29, 0xffff0000, v114
    v_pk_fma_f32 v[36:37], v[28:29], v[16:17], v[36:37] op_sel:[0,0,0] op_sel_hi:[1,0,1]
    v_pk_fma_f32 v[44:45], v[28:29], v[16:17], v[44:45] op_sel:[0,1,0] op_sel_hi:[1,1,1]
    v_lshlrev_b32 v28, 16, v115
    v_and_b32 v29, 0xffff0000, v115
    v_pk_fma_f32 v[38:39], v[28:29], v[16:17], v[38:39] op_sel:[0,0,0] op_sel_hi:[1,0,1]
    v_pk_fma_f32 v[46:47], v[28:29], v[16:17], v[46:47] op_sel:[0,1,0] op_sel_hi:[1,1,1]
    v_lshlrev_b32 v28, 16, v116
    v_and_b32 v29, 0xffff0000, v116
    v_pk_fma_f32 v[32:33], v[28:29], v[18:19], v[32:33] op_sel:[0,0,0] op_sel_hi:[1,0,1]
    v_pk_fma_f32 v[40:41], v[28:29], v[18:19], v[40:41] op_sel:[0,1,0] op_sel_hi:[1,1,1]
    v_lshlrev_b32 v28, 16, v117
    v_and_b32 v29, 0xffff0000, v117
    v_pk_fma_f32 v[34:35], v[28:29], v[18:19], v[34:35] op_sel:[0,0,0] op_sel_hi:[1,0,1]
    v_pk_fma_f32 v[42:43], v[28:29], v[18:19], v[42:43] op_sel:[0,1,0] op_sel_hi:[1,1,1]
    v_lshlrev_b32 v28, 16, v118
    v_and_b32 v29, 0xffff0000, v118
    v_pk_fma_f32 v[36:37], v[28:29], v[18:19], v[36:37] op_sel:[0,0,0] op_sel_hi:[1,0,1]
    v_pk_fma_f32 v[44:45], v[28:29], v[18:19], v[44:45] op_sel:[0,1,0] op_sel_hi:[1,1,1]
    v_lshlrev_b32 v28, 16, v119
    v_and_b32 v29, 0xffff0000, v119
    v_pk_fma_f32 v[38:39], v[28:29], v[18:19], v[38:39] op_sel:[0,0,0] op_sel_hi:[1,0,1]
    v_pk_fma_f32 v[46:47], v[28:29], v[18:19], v[46:47] op_sel:[0,1,0] op_sel_hi:[1,1,1]
    v_lshlrev_b32 v28, 16, v120
    v_and_b32 v29, 0xffff0000, v120
    v_pk_fma_f32 v[32:33], v[28:29], v[20:21], v[32:33] op_sel:[0,0,0] op_sel_hi:[1,0,1]
    v_pk_fma_f32 v[40:41], v[28:29], v[20:21], v[40:41] op_sel:[0,1,0] op_sel_hi:[1,1,1]
    v_lshlrev_b32 v28, 16, v121
    v_and_b32 v29, 0xffff0000, v121
    v_pk_fma_f32 v[34:35], v[28:29], v[20:21], v[34:35] op_sel:[0,0,0] op_sel_hi:[1,0,1]
    v_pk_fma_f32 v[42:43], v[28:29], v[20:21], v[42:43] op_sel:[0,1,0] op_sel_hi:[1,1,1]
    v_lshlrev_b32 v28, 16, v122
    v_and_b32 v29, 0xffff0000, v122
    v_pk_fma_f32 v[36:37], v[28:29], v[20:21], v[36:37] op_sel:[0,0,0] op_sel_hi:[1,0,1]
    v_pk_fma_f32 v[44:45], v[28:29], v[20:21], v[44:45] op_sel:[0,1,0] op_sel_hi:[1,1,1]
    v_lshlrev_b32 v28, 16, v123
    v_and_b32 v29, 0xffff0000, v123
    v_pk_fma_f32 v[38:39], v[28:29], v[20:21], v[38:39] op_sel:[0,0,0] op_sel_hi:[1,0,1]
    v_pk_fma_f32 v[46:47], v[28:29], v[20:21], v[46:47] op_sel:[0,1,0] op_sel_hi:[1,1,1]
    s_nop 1
    v_permlane32_swap_b32 v32, v40
    v_permlane32_swap_b32 v33, v41
    v_permlane32_swap_b32 v34, v42
    v_permlane32_swap_b32 v35, v43
    v_permlane32_swap_b32 v36, v44
    v_permlane32_swap_b32 v37, v45
    v_permlane32_swap_b32 v38, v46
    v_permlane32_swap_b32 v39, v47
    v_add_f32 v32, v32, v40
    v_add_f32 v33, v33, v41
    v_add_f32 v34, v34, v42
    v_add_f32 v35, v35, v43
    v_add_f32 v36, v36, v44
    v_add_f32 v37, v37, v45
    v_add_f32 v38, v38, v46
    v_add_f32 v39, v39, v47
    s_nop 1
    v_permlane16_swap_b32 v32, v36
    v_permlane16_swap_b32 v33, v37
    v_permlane16_swap_b32 v34, v38
    v_permlane16_swap_b32 v35, v39
    v_add_f32 v32, v32, v36
    v_add_f32 v33, v33, v37
    v_add_f32 v34, v34, v38
    v_add_f32 v35, v35, v39
    v_lshrrev_b32 v4, 6, v0
    v_lshlrev_b32 v4, 10, v4
    v_and_b32 v5, 15, v0
    v_lshl_add_u32 v4, v5, 6, v4
    v_bfe_u32 v5, v0, 4, 2
    v_lshl_add_u32 v4, v5, 4, v4
    ds_write_b128 v4, v[32:35] offset:15616
    s_waitcnt lgkmcnt(0)
    s_barrier
    v_cmp_gt_u32 vcc, 64, v0
    s_and_saveexec_b64 s[64:65], vcc
    s_cbranch_execz L_sv_q_end
    v_bfe_u32 v2, v0, 1, 4
    v_lshlrev_b32 v2, 4, v2
    v_lshrrev_b32 v3, 5, v0
    v_lshl_add_u32 v2, v3, 3, v2
    v_and_b32 v4, 1, v0
    v_lshl_add_u32 v2, v4, 2, v2
    v_lshlrev_b32 v2, 2, v2
    ds_read_b128 v[32:35], v2 offset:15616
    ds_read_b128 v[36:39], v2 offset:16640
    ds_read_b128 v[40:43], v2 offset:17664
    ds_read_b128 v[44:47], v2 offset:18688
    ds_read_b128 v[48:51], v2 offset:19712
    ds_read_b128 v[52:55], v2 offset:20736
    ds_read_b128 v[56:59], v2 offset:21760
    ds_read_b128 v[60:63], v2 offset:22784
    ds_read_b128 v[64:67], v2 offset:23808
    ds_read_b128 v[68:71], v2 offset:24832
    ds_read_b128 v[72:75], v2 offset:25856
    ds_read_b128 v[76:79], v2 offset:26880
    ds_read_b128 v[80:83], v2 offset:27904
    ds_read_b128 v[84:87], v2 offset:28928
    ds_read_b128 v[88:91], v2 offset:29952
    ds_read_b128 v[92:95], v2 offset:30976
    s_waitcnt lgkmcnt(0)
    v_pk_add_f32 v[32:33], v[32:33], v[36:37]
    v_pk_add_f32 v[34:35], v[34:35], v[38:39]
    v_pk_add_f32 v[32:33], v[32:33], v[40:41]
    v_pk_add_f32 v[34:35], v[34:35], v[42:43]
    v_pk_add_f32 v[32:33], v[32:33], v[44:45]
    v_pk_add_f32 v[34:35], v[34:35], v[46:47]
    v_pk_add_f32 v[32:33], v[32:33], v[48:49]
    v_pk_add_f32 v[34:35], v[34:35], v[50:51]
    v_pk_add_f32 v[32:33], v[32:33], v[52:53]
    v_pk_add_f32 v[34:35], v[34:35], v[54:55]
    v_pk_add_f32 v[32:33], v[32:33], v[56:57]
    v_pk_add_f32 v[34:35], v[34:35], v[58:59]
    v_pk_add_f32 v[32:33], v[32:33], v[60:61]
    v_pk_add_f32 v[34:35], v[34:35], v[62:63]
    v_pk_add_f32 v[32:33], v[32:33], v[64:65]
    v_pk_add_f32 v[34:35], v[34:35], v[66:67]
    v_pk_add_f32 v[32:33], v[32:33], v[68:69]
    v_pk_add_f32 v[34:35], v[34:35], v[70:71]
    v_pk_add_f32 v[32:33], v[32:33], v[72:73]
    v_pk_add_f32 v[34:35], v[34:35], v[74:75]
    v_pk_add_f32 v[32:33], v[32:33], v[76:77]
    v_pk_add_f32 v[34:35], v[34:35], v[78:79]
    v_pk_add_f32 v[32:33], v[32:33], v[80:81]
    v_pk_add_f32 v[34:35], v[34:35], v[82:83]
    v_pk_add_f32 v[32:33], v[32:33], v[84:85]
    v_pk_add_f32 v[34:35], v[34:35], v[86:87]
    v_pk_add_f32 v[32:33], v[32:33], v[88:89]
    v_pk_add_f32 v[34:35], v[34:35], v[90:91]
    v_pk_add_f32 v[32:33], v[32:33], v[92:93]
    v_pk_add_f32 v[34:35], v[34:35], v[94:95]
    v_cvt_pk_bf16_f32 v32, v32, v33
    v_cvt_pk_bf16_f32 v33, v34, v35
    v_mov_b32 v34, s80
    v_mov_b32 v35, s81
    v_lshlrev_b32 v3, 10, v3
    v_and_b32 v4, 31, v0
    v_add_u32 v3, v3, v4
    s_lshl_b32 s61, s2, 5
    v_add_u32 v3, s61, v3
    v_lshlrev_b32 v3, 4, v3
    v_add_u32 v3, 32768, v3
    global_store_dwordx4 v3, v[32:35], s[42:43] sc1
L_sv_q_end:
    s_mov_b64 exec, s[64:65]
    s_mov_b32 s44, s24
    s_and_b32 s45, s25, 0xffff
    s_mov_b32 s46, 3670016
    s_mov_b32 s47, 0x00020000
    s_mov_b32 s52, s28
    s_and_b32 s53, s29, 0xffff
    s_mov_b32 s54, 1605632
    s_mov_b32 s55, 0x00020000
    v_and_b32 v2, 7, v0
    v_lshrrev_b32 v6, 3, v0
    v_mul_u32_u24 v3, 5376, v6
    v_lshl_add_u32 v3, v2, 4, v3
    s_lshl_b32 s61, s2, 7
    s_add_u32 s61, s61, 1792
    s_cmp_ge_u32 s2, 28
    s_cselect_b32 s61, 0x7f000000, s61
    buffer_load_dwordx4 v[96:99], v3, s[48:51], s61 offen nt
    s_add_u32 s61, s61, 688128
    buffer_load_dwordx4 v[100:103], v3, s[48:51], s61 offen nt
    s_add_u32 s61, s61, 688128
    buffer_load_dwordx4 v[104:107], v3, s[48:51], s61 offen nt
    s_add_u32 s61, s61, 688128
    buffer_load_dwordx4 v[108:111], v3, s[48:51], s61 offen nt
    v_lshlrev_b32 v4, 3, v6
    ds_read_b64 v[24:25], v4 offset:4096
    ds_read_b64 v[26:27], v4 offset:5120
    ds_read_b64 v[28:29], v4 offset:6144
    ds_read_b64 v[30:31], v4 offset:7168
    v_mov_b32 v8, 0
    v_mov_b32 v9, 0
    v_mov_b32 v10, 0
    v_mov_b32 v11, 0
    v_mov_b32 v12, 0
    v_mov_b32 v13, 0
    v_mov_b32 v14, 0
    v_mov_b32 v15, 0
    v_mov_b32 v16, 0
    v_mov_b32 v17, 0
    v_mov_b32 v18, 0
    v_mov_b32 v19, 0
    v_mov_b32 v20, 0
    v_mov_b32 v21, 0
    v_mov_b32 v22, 0
    v_mov_b32 v23, 0
    s_waitcnt vmcnt(0) lgkmcnt(0)
    v_lshlrev_b32 v2, 16, v96
    v_and_b32 v3, 0xffff0000, v96
    v_pk_fma_f32 v[8:9], v[2:3], v[24:25], v[8:9] op_sel:[0,0,0] op_sel_hi:[1,0,1]
    v_pk_fma_f32 v[16:17], v[2:3], v[24:25], v[16:17] op_sel:[0,1,0] op_sel_hi:[1,1,1]
    v_lshlrev_b32 v2, 16, v97
    v_and_b32 v3, 0xffff0000, v97
    v_pk_fma_f32 v[10:11], v[2:3], v[24:25], v[10:11] op_sel:[0,0,0] op_sel_hi:[1,0,1]
    v_pk_fma_f32 v[18:19], v[2:3], v[24:25], v[18:19] op_sel:[0,1,0] op_sel_hi:[1,1,1]
    v_lshlrev_b32 v2, 16, v98
    v_and_b32 v3, 0xffff0000, v98
    v_pk_fma_f32 v[12:13], v[2:3], v[24:25], v[12:13] op_sel:[0,0,0] op_sel_hi:[1,0,1]
    v_pk_fma_f32 v[20:21], v[2:3], v[24:25], v[20:21] op_sel:[0,1,0] op_sel_hi:[1,1,1]
    v_lshlrev_b32 v2, 16, v99
    v_and_b32 v3, 0xffff0000, v99
    v_pk_fma_f32 v[14:15], v[2:3], v[24:25], v[14:15] op_sel:[0,0,0] op_sel_hi:[1,0,1]
    v_pk_fma_f32 v[22:23], v[2:3], v[24:25], v[22:23] op_sel:[0,1,0] op_sel_hi:[1,1,1]
    v_lshlrev_b32 v2, 16, v100
    v_and_b32 v3, 0xffff0000, v100
    v_pk_fma_f32 v[8:9], v[2:3], v[26:27], v[8:9] op_sel:[0,0,0] op_sel_hi:[1,0,1]
    v_pk_fma_f32 v[16:17], v[2:3], v[26:27], v[16:17] op_sel:[0,1,0] op_sel_hi:[1,1,1]
    v_lshlrev_b32 v2, 16, v101
    v_and_b32 v3, 0xffff0000, v101
    v_pk_fma_f32 v[10:11], v[2:3], v[26:27], v[10:11] op_sel:[0,0,0] op_sel_hi:[1,0,1]
    v_pk_fma_f32 v[18:19], v[2:3], v[26:27], v[18:19] op_sel:[0,1,0] op_sel_hi:[1,1,1]
    v_lshlrev_b32 v2, 16, v102
    v_and_b32 v3, 0xffff0000, v102
    v_pk_fma_f32 v[12:13], v[2:3], v[26:27], v[12:13] op_sel:[0,0,0] op_sel_hi:[1,0,1]
    v_pk_fma_f32 v[20:21], v[2:3], v[26:27], v[20:21] op_sel:[0,1,0] op_sel_hi:[1,1,1]
    v_lshlrev_b32 v2, 16, v103
    v_and_b32 v3, 0xffff0000, v103
    v_pk_fma_f32 v[14:15], v[2:3], v[26:27], v[14:15] op_sel:[0,0,0] op_sel_hi:[1,0,1]
    v_pk_fma_f32 v[22:23], v[2:3], v[26:27], v[22:23] op_sel:[0,1,0] op_sel_hi:[1,1,1]
    v_lshlrev_b32 v2, 16, v104
    v_and_b32 v3, 0xffff0000, v104
    v_pk_fma_f32 v[8:9], v[2:3], v[28:29], v[8:9] op_sel:[0,0,0] op_sel_hi:[1,0,1]
    v_pk_fma_f32 v[16:17], v[2:3], v[28:29], v[16:17] op_sel:[0,1,0] op_sel_hi:[1,1,1]
    v_lshlrev_b32 v2, 16, v105
    v_and_b32 v3, 0xffff0000, v105
    v_pk_fma_f32 v[10:11], v[2:3], v[28:29], v[10:11] op_sel:[0,0,0] op_sel_hi:[1,0,1]
    v_pk_fma_f32 v[18:19], v[2:3], v[28:29], v[18:19] op_sel:[0,1,0] op_sel_hi:[1,1,1]
    v_lshlrev_b32 v2, 16, v106
    v_and_b32 v3, 0xffff0000, v106
    v_pk_fma_f32 v[12:13], v[2:3], v[28:29], v[12:13] op_sel:[0,0,0] op_sel_hi:[1,0,1]
    v_pk_fma_f32 v[20:21], v[2:3], v[28:29], v[20:21] op_sel:[0,1,0] op_sel_hi:[1,1,1]
    v_lshlrev_b32 v2, 16, v107
    v_and_b32 v3, 0xffff0000, v107
    v_pk_fma_f32 v[14:15], v[2:3], v[28:29], v[14:15] op_sel:[0,0,0] op_sel_hi:[1,0,1]
    v_pk_fma_f32 v[22:23], v[2:3], v[28:29], v[22:23] op_sel:[0,1,0] op_sel_hi:[1,1,1]
    v_lshlrev_b32 v2, 16, v108
    v_and_b32 v3, 0xffff0000, v108
    v_pk_fma_f32 v[8:9], v[2:3], v[30:31], v[8:9] op_sel:[0,0,0] op_sel_hi:[1,0,1]
    v_pk_fma_f32 v[16:17], v[2:3], v[30:31], v[16:17] op_sel:[0,1,0] op_sel_hi:[1,1,1]
    v_lshlrev_b32 v2, 16, v109
    v_and_b32 v3, 0xffff0000, v109
    v_pk_fma_f32 v[10:11], v[2:3], v[30:31], v[10:11] op_sel:[0,0,0] op_sel_hi:[1,0,1]
    v_pk_fma_f32 v[18:19], v[2:3], v[30:31], v[18:19] op_sel:[0,1,0] op_sel_hi:[1,1,1]
    v_lshlrev_b32 v2, 16, v110
    v_and_b32 v3, 0xffff0000, v110
    v_pk_fma_f32 v[12:13], v[2:3], v[30:31], v[12:13] op_sel:[0,0,0] op_sel_hi:[1,0,1]
    v_pk_fma_f32 v[20:21], v[2:3], v[30:31], v[20:21] op_sel:[0,1,0] op_sel_hi:[1,1,1]
    v_lshlrev_b32 v2, 16, v111
    v_and_b32 v3, 0xffff0000, v111
    v_pk_fma_f32 v[14:15], v[2:3], v[30:31], v[14:15] op_sel:[0,0,0] op_sel_hi:[1,0,1]
    v_pk_fma_f32 v[22:23], v[2:3], v[30:31], v[22:23] op_sel:[0,1,0] op_sel_hi:[1,1,1]
    s_nop 1
    v_add_f32_dpp v8, v8, v8 row_ror:8 row_mask:0xf bank_mask:0xf
    v_add_f32_dpp v9, v9, v9 row_ror:8 row_mask:0xf bank_mask:0xf
    v_add_f32_dpp v10, v10, v10 row_ror:8 row_mask:0xf bank_mask:0xf
    v_add_f32_dpp v11, v11, v11 row_ror:8 row_mask:0xf bank_mask:0xf
    v_add_f32_dpp v12, v12, v12 row_ror:8 row_mask:0xf bank_mask:0xf
    v_add_f32_dpp v13, v13, v13 row_ror:8 row_mask:0xf bank_mask:0xf
    v_add_f32_dpp v14, v14, v14 row_ror:8 row_mask:0xf bank_mask:0xf
    v_add_f32_dpp v15, v15, v15 row_ror:8 row_mask:0xf bank_mask:0xf
    v_add_f32_dpp v16, v16, v16 row_ror:8 row_mask:0xf bank_mask:0xf
    v_add_f32_dpp v17, v17, v17 row_ror:8 row_mask:0xf bank_mask:0xf
    v_add_f32_dpp v18, v18, v18 row_ror:8 row_mask:0xf bank_mask:0xf
    v_add_f32_dpp v19, v19, v19 row_ror:8 row_mask:0xf bank_mask:0xf
    v_add_f32_dpp v20, v20, v20 row_ror:8 row_mask:0xf bank_mask:0xf
    v_add_f32_dpp v21, v21, v21 row_ror:8 row_mask:0xf bank_mask:0xf
    v_add_f32_dpp v22, v22, v22 row_ror:8 row_mask:0xf bank_mask:0xf
    v_add_f32_dpp v23, v23, v23 row_ror:8 row_mask:0xf bank_mask:0xf
    s_nop 1
    v_permlane32_swap_b32 v8, v16
    v_permlane32_swap_b32 v9, v17
    v_permlane32_swap_b32 v10, v18
    v_permlane32_swap_b32 v11, v19
    v_permlane32_swap_b32 v12, v20
    v_permlane32_swap_b32 v13, v21
    v_permlane32_swap_b32 v14, v22
    v_permlane32_swap_b32 v15, v23
    v_add_f32 v8, v8, v16
    v_add_f32 v9, v9, v17
    v_add_f32 v10, v10, v18
    v_add_f32 v11, v11, v19
    v_add_f32 v12, v12, v20
    v_add_f32 v13, v13, v21
    v_add_f32 v14, v14, v22
    v_add_f32 v15, v15, v23
    s_nop 1
    v_permlane16_swap_b32 v8, v12
    v_permlane16_swap_b32 v9, v13
    v_permlane16_swap_b32 v10, v14
    v_permlane16_swap_b32 v11, v15
    v_add_f32 v8, v8, v12
    v_add_f32 v9, v9, v13
    v_add_f32 v10, v10, v14
    v_add_f32 v11, v11, v15
    v_lshrrev_b32 v4, 6, v0
    v_lshlrev_b32 v4, 9, v4
    v_and_b32 v5, 7, v0
    v_lshl_add_u32 v4, v5, 6, v4
    v_bfe_u32 v5, v0, 4, 2
    v_lshl_add_u32 v4, v5, 4, v4
    ds_write_b128 v4, v[8:11] offset:37120
    s_waitcnt lgkmcnt(0)
    s_barrier
    s_cmp_ge_u32 s2, 28
    s_cbranch_scc1 L_sv_modn_done
    v_cmp_gt_u32 vcc, 64, v0
    s_and_saveexec_b64 s[64:65], vcc
    s_cbranch_execz L_sv_modn_end
    v_lshrrev_b32 v2, 3, v0
    v_lshlrev_b32 v2, 4, v2
    v_and_b32 v3, 7, v0
    v_add_u32 v2, v2, v3
    v_lshlrev_b32 v2, 2, v2
    ds_read_b32 v8, v2 offset:37120
    ds_read_b32 v96, v2 offset:37152
    ds_read_b32 v9, v2 offset:37632
    ds_read_b32 v97, v2 offset:37664
    ds_read_b32 v10, v2 offset:38144
    ds_read_b32 v98, v2 offset:38176
    ds_read_b32 v11, v2 offset:38656
    ds_read_b32 v99, v2 offset:38688
    ds_read_b32 v12, v2 offset:39168
    ds_read_b32 v100, v2 offset:39200
    ds_read_b32 v13, v2 offset:39680
    ds_read_b32 v101, v2 offset:39712
    ds_read_b32 v14, v2 offset:40192
    ds_read_b32 v102, v2 offset:40224
    ds_read_b32 v15, v2 offset:40704
    ds_read_b32 v103, v2 offset:40736
    ds_read_b32 v16, v2 offset:41216
    ds_read_b32 v104, v2 offset:41248
    ds_read_b32 v17, v2 offset:41728
    ds_read_b32 v105, v2 offset:41760
    ds_read_b32 v18, v2 offset:42240
    ds_read_b32 v106, v2 offset:42272
    ds_read_b32 v19, v2 offset:42752
    ds_read_b32 v107, v2 offset:42784
    ds_read_b32 v20, v2 offset:43264
    ds_read_b32 v108, v2 offset:43296
    ds_read_b32 v21, v2 offset:43776
    ds_read_b32 v109, v2 offset:43808
    ds_read_b32 v22, v2 offset:44288
    ds_read_b32 v110, v2 offset:44320
    ds_read_b32 v23, v2 offset:44800
    ds_read_b32 v111, v2 offset:44832
    s_waitcnt lgkmcnt(0)
    v_add_f32 v8, v8, v9
    v_add_f32 v96, v96, v97
    v_add_f32 v8, v8, v10
    v_add_f32 v96, v96, v98
    v_add_f32 v8, v8, v11
    v_add_f32 v96, v96, v99
    v_add_f32 v8, v8, v12
    v_add_f32 v96, v96, v100
    v_add_f32 v8, v8, v13
    v_add_f32 v96, v96, v101
    v_add_f32 v8, v8, v14
    v_add_f32 v96, v96, v102
    v_add_f32 v8, v8, v15
    v_add_f32 v96, v96, v103
    v_add_f32 v8, v8, v16
    v_add_f32 v96, v96, v104
    v_add_f32 v8, v8, v17
    v_add_f32 v96, v96, v105
    v_add_f32 v8, v8, v18
    v_add_f32 v96, v96, v106
    v_add_f32 v8, v8, v19
    v_add_f32 v96, v96, v107
    v_add_f32 v8, v8, v20
    v_add_f32 v96, v96, v108
    v_add_f32 v8, v8, v21
    v_add_f32 v96, v96, v109
    v_add_f32 v8, v8, v22
    v_add_f32 v96, v96, v110
    v_add_f32 v8, v8, v23
    v_add_f32 v96, v96, v111
    v_cvt_pk_bf16_f32 v4, v8, v8
    v_lshlrev_b32 v8, 16, v4
    v_cvt_pk_bf16_f32 v4, v96, v96
    v_lshlrev_b32 v96, 16, v4
    v_mov_b32 v9, v96
    v_mov_b32 v10, s80
    v_mov_b32 v11, s81
    s_lshl_b32 s61, s2, 6
    v_add_u32 v3, s61, v0
    v_lshlrev_b32 v3, 4, v3
    v_add_u32 v3, 65536, v3
    global_store_dwordx4 v3, v[8:11], s[42:43] sc1
L_sv_modn_end:
    s_mov_b64 exec, s[64:65]
L_sv_modn_done:
    s_mov_b32 s44, s28
    s_and_b32 s45, s29, 0xffff
    s_mov_b32 s46, 1605632
    s_mov_b32 s47, 0x00020000
    s_mov_b32 s52, s30
    s_and_b32 s53, s31, 0xffff
    s_mov_b32 s54, 1605632
    s_mov_b32 s55, 0x00020000
    s_mov_b32 s68, s32
    s_and_b32 s69, s33, 0xffff
    s_mov_b32 s70, 1605632
    s_mov_b32 s71, 0x00020000
    v_bfe_u32 v24, v0, 4, 2
    v_lshlrev_b32 v24, 3, v24
    v_bfe_u32 v25, v0, 2, 2
    v_add_u32 v24, v24, v25
    v_and_b32 v25, 3, v0
    v_lshlrev_b32 v25, 3, v25
    s_waitcnt vmcnt(0)
    s_barrier
    s_cmp_ge_u32 s60, 14
    s_cbranch_scc1 L_sv_w1_skip
    v_mul_u32_u24 v3, 448, v24
    v_add_u32 v3, v3, v25
    s_lshl_b32 s61, s60, 5
    s_add_u32 s61, s61, 45824
    v_add_u32 v3, s61, v3
    v_add_u32 v2, 57344, v3
    ds_read_b64_tr_b16 v[32:33], v3 offset:0
    ds_read_b64_tr_b16 v[34:35], v3 offset:1792
    ds_read_b64_tr_b16 v[36:37], v3 offset:14336
    ds_read_b64_tr_b16 v[38:39], v3 offset:16128
    ds_read_b64_tr_b16 v[40:41], v3 offset:28672
    ds_read_b64_tr_b16 v[42:43], v3 offset:30464
    ds_read_b64_tr_b16 v[44:45], v3 offset:43008
    ds_read_b64_tr_b16 v[46:47], v3 offset:44800
    ds_read_b64_tr_b16 v[48:49], v2 offset:0
    ds_read_b64_tr_b16 v[50:51], v2 offset:1792
    ds_read_b64_tr_b16 v[52:53], v2 offset:14336
    ds_read_b64_tr_b16 v[54:55], v2 offset:16128
    ds_read_b64_tr_b16 v[56:57], v2 offset:28672
    ds_read_b64_tr_b16 v[58:59], v2 offset:30464
    ds_read_b64_tr_b16 v[60:61], v2 offset:43008
    ds_read_b64_tr_b16 v[62:63], v2 offset:44800
L_sv_w1_skip:
    s_waitcnt lgkmcnt(0)
    s_barrier
    s_cmp_ge_u32 s2, 28
    s_cbranch_scc1 L_sv_w23_skip
    v_lshrrev_b32 v3, 3, v1
    v_mul_u32_u24 v3, 3584, v3
    v_and_b32 v4, 7, v1
    v_lshl_add_u32 v3, v4, 4, v3
    s_and_b32 s61, s60, 7
    s_mul_i32 s62, s61, 200704
    s_lshl_b32 s63, s2, 7
    s_add_u32 s62, s62, s63
    s_mul_i32 s61, s60, 7168
    s_add_u32 s61, s61, 45824
    s_cmp_ge_u32 s60, 8
    s_cbranch_scc1 L_sv_w2_up
    s_mov_b32 m0, s61
    s_add_u32 s61, s61, 1024
    buffer_load_dwordx4 v3, s[44:47], s62 offen nt lds
    s_add_u32 s62, s62, 28672
    s_mov_b32 m0, s61
    s_add_u32 s61, s61, 1024
    buffer_load_dwordx4 v3, s[44:47], s62 offen nt lds
    s_add_u32 s62, s62, 28672
    s_mov_b32 m0, s61
    s_add_u32 s61, s61, 1024
    buffer_load_dwordx4 v3, s[44:47], s62 offen nt lds
    s_add_u32 s62, s62, 28672
    s_mov_b32 m0, s61
    s_add_u32 s61, s61, 1024
    buffer_load_dwordx4 v3, s[44:47], s62 offen nt lds
    s_add_u32 s62, s62, 28672
    s_mov_b32 m0, s61
    s_add_u32 s61, s61, 1024
    buffer_load_dwordx4 v3, s[44:47], s62 offen nt lds
    s_add_u32 s62, s62, 28672
    s_mov_b32 m0, s61
    s_add_u32 s61, s61, 1024
    buffer_load_dwordx4 v3, s[44:47], s62 offen nt lds
    s_add_u32 s62, s62, 28672
    s_mov_b32 m0, s61
    s_add_u32 s61, s61, 1024
    buffer_load_dwordx4 v3, s[44:47], s62 offen nt lds
    s_add_u32 s62, s62, 28672
    s_branch L_sv_w2_done
L_sv_w2_up:
    s_mov_b32 m0, s61
    s_add_u32 s61, s61, 1024
    buffer_load_dwordx4 v3, s[52:55], s62 offen nt lds
    s_add_u32 s62, s62, 28672
    s_mov_b32 m0, s61
    s_add_u32 s61, s61, 1024
    buffer_load_dwordx4 v3, s[52:55], s62 offen nt lds
    s_add_u32 s62, s62, 28672
    s_mov_b32 m0, s61
    s_add_u32 s61, s61, 1024
    buffer_load_dwordx4 v3, s[52:55], s62 offen nt lds
    s_add_u32 s62, s62, 28672
    s_mov_b32 m0, s61
    s_add_u32 s61, s61, 1024
    buffer_load_dwordx4 v3, s[52:55], s62 offen nt lds
    s_add_u32 s62, s62, 28672
    s_mov_b32 m0, s61
    s_add_u32 s61, s61, 1024
    buffer_load_dwordx4 v3, s[52:55], s62 offen nt lds
    s_add_u32 s62, s62, 28672
    s_mov_b32 m0, s61
    s_add_u32 s61, s61, 1024
    buffer_load_dwordx4 v3, s[52:55], s62 offen nt lds
    s_add_u32 s62, s62, 28672
    s_mov_b32 m0, s61
    s_add_u32 s61, s61, 1024
    buffer_load_dwordx4 v3, s[52:55], s62 offen nt lds
    s_add_u32 s62, s62, 28672
L_sv_w2_done:
    s_waitcnt vmcnt(0)
    s_barrier
    v_lshlrev_b32 v3, 7, v24
    v_add_u32 v3, v3, v25
    s_and_b32 s61, s60, 3
    s_lshl_b32 s61, s61, 5
    s_bfe_u32 s62, s60, 0x10002
    s_mul_i32 s62, s62, 57344
    s_add_u32 s61, s61, s62
    s_lshr_b32 s62, s60, 3
    s_mul_i32 s62, s62, 28672
    s_add_u32 s61, s61, s62
    s_add_u32 s61, s61, 45824
    v_add_u32 v3, s61, v3
    ds_read_b64_tr_b16 v[64:65], v3 offset:0
    ds_read_b64_tr_b16 v[66:67], v3 offset:512
    ds_read_b64_tr_b16 v[68:69], v3 offset:4096
    ds_read_b64_tr_b16 v[70:71], v3 offset:4608
    ds_read_b64_tr_b16 v[72:73], v3 offset:8192
    ds_read_b64_tr_b16 v[74:75], v3 offset:8704
    ds_read_b64_tr_b16 v[76:77], v3 offset:12288
    ds_read_b64_tr_b16 v[78:79], v3 offset:12800
    ds_read_b64_tr_b16 v[80:81], v3 offset:16384
    ds_read_b64_tr_b16 v[82:83], v3 offset:16896
    ds_read_b64_tr_b16 v[84:85], v3 offset:20480
    ds_read_b64_tr_b16 v[86:87], v3 offset:20992
    ds_read_b64_tr_b16 v[88:89], v3 offset:24576
    ds_read_b64_tr_b16 v[90:91], v3 offset:25088
    s_waitcnt lgkmcnt(0)
    s_barrier
    s_cmp_ge_u32 s60, 14
    s_cbranch_scc1 L_sv_w3_nodma
    v_lshlrev_b32 v3, 4, v1
    s_mul_i32 s62, s2, 57344
    s_lshl_b32 s61, s60, 12
    s_add_u32 s62, s62, s61
    s_add_u32 s61, s61, 45824
    s_mov_b32 m0, s61
    s_add_u32 s61, s61, 1024
    buffer_load_dwordx4 v3, s[68:71], s62 offen nt lds
    s_add_u32 s62, s62, 1024
    s_mov_b32 m0, s61
    s_add_u32 s61, s61, 1024
    buffer_load_dwordx4 v3, s[68:71], s62 offen nt lds
    s_add_u32 s62, s62, 1024
    s_mov_b32 m0, s61
    s_add_u32 s61, s61, 1024
    buffer_load_dwordx4 v3, s[68:71], s62 offen nt lds
    s_add_u32 s62, s62, 1024
    s_mov_b32 m0, s61
    s_add_u32 s61, s61, 1024
    buffer_load_dwordx4 v3, s[68:71], s62 offen nt lds
    s_add_u32 s62, s62, 1024
L_sv_w3_nodma:
    s_waitcnt vmcnt(0)
    s_barrier
    v_mul_u32_u24 v3, 896, v24
    v_add_u32 v3, v3, v25
    s_lshl_b32 s61, s60, 5
    s_add_u32 s61, s61, 45824
    v_add_u32 v3, s61, v3
    ds_read_b64_tr_b16 v[112:113], v3 offset:0
    ds_read_b64_tr_b16 v[114:115], v3 offset:3584
    ds_read_b64_tr_b16 v[116:117], v3 offset:28672
    ds_read_b64_tr_b16 v[118:119], v3 offset:32256
    ds_read_b64_tr_b16 v[120:121], v3 offset:512
    ds_read_b64_tr_b16 v[122:123], v3 offset:4096
    ds_read_b64_tr_b16 v[124:125], v3 offset:29184
    ds_read_b64_tr_b16 v[126:127], v3 offset:32768
L_sv_w23_skip:
    s_waitcnt lgkmcnt(0)
    v_mov_b32 v31, 0
    s_cmp_lt_u32 s60, 8
    s_cbranch_scc1 L_sv_modn_skip
    s_cmp_ge_u32 s60, 12
    s_cbranch_scc1 L_sv_modn_skip
    s_sub_u32 s61, s60, 8
    s_mul_i32 s62, s61, 7168
    v_lshlrev_b32 v4, 4, v1
    v_add_u32 v4, s62, v4
    v_add_u32 v4, 65536, v4
    v_add_u32 v5, 4096, v4
    s_mul_i32 s62, s61, 3584
    v_lshl_add_u32 v6, v1, 2, s62
    s_mov_b32 s79, 20000
L_poll_modn:
    global_load_dwordx4 v[8:11], v4, s[42:43] offset:0 sc1
    global_load_dwordx4 v[12:15], v4, s[42:43] offset:1024 sc1
    global_load_dwordx4 v[16:19], v4, s[42:43] offset:2048 sc1
    global_load_dwordx4 v[20:23], v4, s[42:43] offset:3072 sc1
    global_load_dwordx4 v[24:27], v5, s[42:43] offset:0 sc1
    global_load_dwordx4 v[96:99], v5, s[42:43] offset:1024 sc1
    global_load_dwordx4 v[100:103], v5, s[42:43] offset:2048 sc1
    s_waitcnt vmcnt(0)
    v_xor_b32 v2, s80, v10
    v_xor_b32 v3, s81, v11
    v_or_b32 v2, v2, v3
    v_xor_b32 v3, s80, v14
    v_or_b32 v2, v2, v3
    v_xor_b32 v3, s81, v15
    v_or_b32 v2, v2, v3
    v_xor_b32 v3, s80, v18
    v_or_b32 v2, v2, v3
    v_xor_b32 v3, s81, v19
    v_or_b32 v2, v2, v3
    v_xor_b32 v3, s80, v22
    v_or_b32 v2, v2, v3
    v_xor_b32 v3, s81, v23
    v_or_b32 v2, v2, v3
    v_xor_b32 v3, s80, v26
    v_or_b32 v2, v2, v3
    v_xor_b32 v3, s81, v27
    v_or_b32 v2, v2, v3
    v_xor_b32 v3, s80, v98
    v_or_b32 v2, v2, v3
    v_xor_b32 v3, s81, v99
    v_or_b32 v2, v2, v3
    v_xor_b32 v3, s80, v102
    v_or_b32 v2, v2, v3
    v_xor_b32 v3, s81, v103
    v_or_b32 v2, v2, v3
    v_cmp_ne_u32 vcc, 0, v2
    s_cbranch_vccz L_pollok_modn
    s_sleep 1
    s_sub_u32 s79, s79, 1
    s_cmp_lg_u32 s79, 0
    s_cbranch_scc1 L_poll_modn
L_pollok_modn:
    ds_write_b32 v6, v8 offset:22784
    ds_write_b32 v6, v9 offset:24576
    ds_write_b32 v6, v12 offset:23040
    ds_write_b32 v6, v13 offset:24832
    ds_write_b32 v6, v16 offset:23296
    ds_write_b32 v6, v17 offset:25088
    ds_write_b32 v6, v20 offset:23552
    ds_write_b32 v6, v21 offset:25344
    ds_write_b32 v6, v24 offset:23808
    ds_write_b32 v6, v25 offset:25600
    ds_write_b32 v6, v96 offset:24064
    ds_write_b32 v6, v97 offset:25856
    ds_write_b32 v6, v100 offset:24320
    ds_write_b32 v6, v101 offset:26112
L_sv_modn_skip:
    s_cmp_lt_u32 s60, 4
    s_cbranch_scc1 L_sv_part_skip
    s_cmp_ge_u32 s60, 8
    s_cbranch_scc1 L_sv_part_skip
    s_lshr_b32 s61, s2, 1
    v_bfe_u32 v2, v0, 7, 1
    v_lshlrev_b32 v2, 4, v2
    v_add_u32 v2, s61, v2
    v_mul_u32_u24 v2, 14784, v2
    v_add_u32 v2, 131072, v2
    v_and_b32 v3, 127, v0
    v_lshl_add_u32 v3, v3, 4, v2
    v_add_u32 v4, 4224, v3
    v_add_u32 v5, 8448, v3
    v_add_u32 v6, 12672, v3
    v_add_u32 v25, 2048, v2
    v_add_u32 v26, 6272, v2
    v_add_u32 v27, 10496, v2
    v_add_u32 v28, 14720, v2
    s_mov_b32 s79, 20000
L_poll_ml:
    global_load_dwordx4 v[8:11], v25, s[42:43] offset:0 sc1
    global_load_dwordx4 v[12:15], v25, s[42:43] offset:2112 sc1
    global_load_dwordx4 v[16:19], v26, s[42:43] offset:0 sc1
    global_load_dwordx4 v[20:23], v26, s[42:43] offset:2112 sc1
    global_load_dwordx4 v[96:99], v27, s[42:43] offset:0 sc1
    global_load_dwordx4 v[100:103], v27, s[42:43] offset:2112 sc1
    global_load_dwordx4 v[104:107], v28, s[42:43] offset:0 sc1
    s_waitcnt vmcnt(0)
    v_xor_b32 v29, s80, v10
    v_xor_b32 v30, s81, v11
    v_or_b32 v29, v29, v30
    v_xor_b32 v30, s80, v14
    v_or_b32 v29, v29, v30
    v_xor_b32 v30, s81, v15
    v_or_b32 v29, v29, v30
    v_xor_b32 v30, s80, v18
    v_or_b32 v29, v29, v30
    v_xor_b32 v30, s81, v19
    v_or_b32 v29, v29, v30
    v_xor_b32 v30, s80, v22
    v_or_b32 v29, v29, v30
    v_xor_b32 v30, s81, v23
    v_or_b32 v29, v29, v30
    v_xor_b32 v30, s80, v98
    v_or_b32 v29, v29, v30
    v_xor_b32 v30, s81, v99
    v_or_b32 v29, v29, v30
    v_xor_b32 v30, s80, v102
    v_or_b32 v29, v29, v30
    v_xor_b32 v30, s81, v103
    v_or_b32 v29, v29, v30
    v_xor_b32 v30, s80, v106
    v_or_b32 v29, v29, v30
    v_xor_b32 v30, s81, v107
    v_or_b32 v29, v29, v30
    v_cmp_ne_u32 vcc, 0, v29
    s_cbranch_vccz L_pollok_ml
    s_sleep 4
    s_sub_u32 s79, s79, 1
    s_cmp_lg_u32 s79, 0
    s_cbranch_scc1 L_poll_ml
L_pollok_ml:
    v_max_f32 v29, v8, v12
    v_max_f32 v29, v29, v16
    v_max_f32 v29, v29, v20
    v_max_f32 v29, v29, v96
    v_max_f32 v29, v29, v100
    v_max_f32 v29, v29, v104
    v_sub_f32 v8, v8, v29
    v_exp_f32 v8, v8
    v_sub_f32 v12, v12, v29
    v_exp_f32 v12, v12
    v_sub_f32 v16, v16, v29
    v_exp_f32 v16, v16
    v_sub_f32 v20, v20, v29
    v_exp_f32 v20, v20
    v_sub_f32 v96, v96, v29
    v_exp_f32 v96, v96
    v_sub_f32 v100, v100, v29
    v_exp_f32 v100, v100
    v_sub_f32 v104, v104, v29
    v_exp_f32 v104, v104
    s_nop 0
    v_mul_f32 v29, v8, v9
    v_fmac_f32 v29, v12, v13
    v_fmac_f32 v29, v16, v17
    v_fmac_f32 v29, v20, v21
    v_fmac_f32 v29, v96, v97
    v_fmac_f32 v29, v100, v101
    v_fmac_f32 v29, v104, v105
    v_mov_b32 v23, v12
    v_mov_b32 v30, v16
    v_mov_b32 v31, v20
    v_mov_b32 v9, v23
    v_mov_b32 v10, v30
    v_mov_b32 v11, v31
    v_mov_b32 v12, v96
    v_mov_b32 v13, v100
    v_mov_b32 v14, v104
    v_mov_b32 v15, v29
    s_mov_b32 s79, 20000
    s_mov_b64 s[74:75], exec
    global_load_dwordx4 v[96:99], v3, s[42:43] offset:0 sc1
    global_load_dwordx4 v[100:103], v3, s[42:43] offset:2112 sc1
    global_load_dwordx4 v[104:107], v4, s[42:43] offset:0 sc1
    global_load_dwordx4 v[108:111], v4, s[42:43] offset:2112 sc1
    global_load_dwordx4 v[16:19], v5, s[42:43] offset:0 sc1
    global_load_dwordx4 v[20:23], v5, s[42:43] offset:2112 sc1
    global_load_dwordx4 v[24:27], v6, s[42:43] offset:0 sc1
L_pm_pa:
    s_waitcnt vmcnt(0)
    v_xor_b32 v30, s80, v98
    v_xor_b32 v31, s81, v99
    v_or_b32 v30, v30, v31
    v_cmp_ne_u32 s[44:45], 0, v30
    v_xor_b32 v30, s80, v102
    v_xor_b32 v31, s81, v103
    v_or_b32 v30, v30, v31
    v_cmp_ne_u32 s[46:47], 0, v30
    v_xor_b32 v30, s80, v106
    v_xor_b32 v31, s81, v107
    v_or_b32 v30, v30, v31
    v_cmp_ne_u32 s[48:49], 0, v30
    v_xor_b32 v30, s80, v110
    v_xor_b32 v31, s81, v111
    v_or_b32 v30, v30, v31
    v_cmp_ne_u32 s[50:51], 0, v30
    v_xor_b32 v30, s80, v18
    v_xor_b32 v31, s81, v19
    v_or_b32 v30, v30, v31
    v_cmp_ne_u32 s[52:53], 0, v30
    v_xor_b32 v30, s80, v22
    v_xor_b32 v31, s81, v23
    v_or_b32 v30, v30, v31
    v_cmp_ne_u32 s[54:55], 0, v30
    v_xor_b32 v30, s80, v26
    v_xor_b32 v31, s81, v27
    v_or_b32 v30, v30, v31
    v_cmp_ne_u32 s[68:69], 0, v30
    s_mov_b64 s[72:73], s[44:45]
    s_or_b64 s[72:73], s[72:73], s[46:47]
    s_or_b64 s[72:73], s[72:73], s[48:49]
    s_or_b64 s[72:73], s[72:73], s[50:51]
    s_or_b64 s[72:73], s[72:73], s[52:53]
    s_or_b64 s[72:73], s[72:73], s[54:55]
    s_or_b64 s[72:73], s[72:73], s[68:69]
    s_cmp_eq_u64 s[72:73], 0
    s_cbranch_scc1 L_pmok_pa
    s_sub_u32 s79, s79, 1
    s_cmp_eq_u32 s79, 0
    s_cbranch_scc1 L_pmok_pa
    s_mov_b64 exec, s[44:45]
    s_cbranch_execz L_pmsk_pa_0
    global_load_dwordx4 v[96:99], v3, s[42:43] offset:0 sc1
L_pmsk_pa_0:
    s_mov_b64 exec, s[46:47]
    s_cbranch_execz L_pmsk_pa_1
    global_load_dwordx4 v[100:103], v3, s[42:43] offset:2112 sc1
L_pmsk_pa_1:
    s_mov_b64 exec, s[48:49]
    s_cbranch_execz L_pmsk_pa_2
    global_load_dwordx4 v[104:107], v4, s[42:43] offset:0 sc1
L_pmsk_pa_2:
    s_mov_b64 exec, s[50:51]
    s_cbranch_execz L_pmsk_pa_3
    global_load_dwordx4 v[108:111], v4, s[42:43] offset:2112 sc1
L_pmsk_pa_3:
    s_mov_b64 exec, s[52:53]
    s_cbranch_execz L_pmsk_pa_4
    global_load_dwordx4 v[16:19], v5, s[42:43] offset:0 sc1
L_pmsk_pa_4:
    s_mov_b64 exec, s[54:55]
    s_cbranch_execz L_pmsk_pa_5
    global_load_dwordx4 v[20:23], v5, s[42:43] offset:2112 sc1
L_pmsk_pa_5:
    s_mov_b64 exec, s[68:69]
    s_cbranch_execz L_pmsk_pa_6
    global_load_dwordx4 v[24:27], v6, s[42:43] offset:0 sc1
L_pmsk_pa_6:
    s_mov_b64 exec, s[74:75]
    s_branch L_pm_pa
L_pmok_pa:
    s_mov_b64 exec, s[74:75]
    v_mul_f32 v28, v8, v96
    v_mul_f32 v29, v8, v97
    v_fmac_f32 v28, v9, v100
    v_fmac_f32 v29, v9, v101
    v_fmac_f32 v28, v10, v104
    v_fmac_f32 v29, v10, v105
    v_fmac_f32 v28, v11, v108
    v_fmac_f32 v29, v11, v109
    v_fmac_f32 v28, v12, v16
    v_fmac_f32 v29, v12, v17
    v_fmac_f32 v28, v13, v20
    v_fmac_f32 v29, v13, v21
    v_fmac_f32 v28, v14, v24
    v_fmac_f32 v29, v14, v25
    v_rcp_f32 v30, v15
    s_nop 0
    v_mul_f32 v12, v28, v30
    v_fma_f32 v13, -v12, v15, v28
    v_fmac_f32 v12, v13, v30
    v_mul_f32 v16, v29, v30
    v_fma_f32 v13, -v16, v15, v29
    v_fmac_f32 v16, v13, v30
    v_cvt_pk_bf16_f32 v12, v12, v16
    v_and_b32 v3, 127, v0
    v_lshlrev_b32 v3, 2, v3
    v_bfe_u32 v2, v0, 7, 1
    v_lshl_add_u32 v3, v2, 9, v3
    ds_write_b32 v3, v12 offset:40704
    v_mov_b32 v31, 0
L_sv_part_skip:
    s_waitcnt lgkmcnt(0)
    s_barrier
    s_cmp_ge_u32 s60, 14
    s_cbranch_scc1 L_sv_att_skip
    v_and_b32 v2, 1, v0
    v_lshlrev_b32 v2, 9, v2
    v_bfe_u32 v3, v0, 4, 2
    v_lshl_add_u32 v2, v3, 4, v2
    ds_read_b128 v[12:15], v2 offset:40704
    ds_read_b128 v[16:19], v2 offset:40768
    ds_read_b128 v[20:23], v2 offset:40832
    ds_read_b128 v[24:27], v2 offset:40896
    ds_read_b128 v[28:31], v2 offset:40960
    ds_read_b128 v[96:99], v2 offset:41024
    ds_read_b128 v[100:103], v2 offset:41088
    ds_read_b128 v[104:107], v2 offset:41152
    v_mov_b32 v8, 0
    v_mov_b32 v9, 0
    v_mov_b32 v10, 0
    v_mov_b32 v11, 0
    s_nop 1
    s_waitcnt lgkmcnt(7)
    v_mfma_f32_16x16x32_bf16 v[8:11], v[12:15], v[32:35], v[8:11]
    s_waitcnt lgkmcnt(6)
    v_mfma_f32_16x16x32_bf16 v[8:11], v[16:19], v[36:39], v[8:11]
    s_waitcnt lgkmcnt(5)
    v_mfma_f32_16x16x32_bf16 v[8:11], v[20:23], v[40:43], v[8:11]
    s_waitcnt lgkmcnt(4)
    v_mfma_f32_16x16x32_bf16 v[8:11], v[24:27], v[44:47], v[8:11]
    s_waitcnt lgkmcnt(3)
    v_mfma_f32_16x16x32_bf16 v[8:11], v[28:31], v[48:51], v[8:11]
    s_waitcnt lgkmcnt(2)
    v_mfma_f32_16x16x32_bf16 v[8:11], v[96:99], v[52:55], v[8:11]
    s_waitcnt lgkmcnt(1)
    v_mfma_f32_16x16x32_bf16 v[8:11], v[100:103], v[56:59], v[8:11]
    s_waitcnt lgkmcnt(0)
    v_mfma_f32_16x16x32_bf16 v[8:11], v[104:107], v[60:63], v[8:11]
    s_lshr_b32 s61, s2, 1
    s_mul_i32 s61, s61, 448
    s_and_b32 s62, s2, 1
    s_mul_i32 s62, s62, 224
    s_add_u32 s61, s61, s62
    s_lshl_b32 s62, s60, 4
    s_add_u32 s61, s61, s62
    v_add_u32 v2, s61, v1
    v_lshlrev_b32 v2, 4, v2
    v_add_u32 v2, 655360, v2
    v_cmp_gt_u32 vcc, 16, v1
    s_and_saveexec_b64 s[64:65], vcc
    s_nop 4
    v_mov_b32 v10, s80
    v_mov_b32 v11, s81
    global_store_dwordx4 v2, v[8:11], s[42:43] sc1
    s_mov_b64 exec, s[64:65]
L_sv_att_skip:
    s_cmp_ge_u32 s2, 28
    s_cbranch_scc1 L_sv_exit
    v_cmp_gt_u32 vcc, 896, v0
    s_and_saveexec_b64 s[64:65], vcc
    s_cbranch_execz L_sv_h2_end
    v_cmp_le_u32 vcc, 448, v0
    s_nop 1
    v_cndmask_b32 v2, 0, 1, vcc
    v_mul_u32_u24 v3, 448, v2
    v_sub_u32 v3, v0, v3
    v_mul_u32_u24 v4, 3584, v2
    v_add_u32 v4, v4, v3
    v_lshlrev_b32 v4, 4, v4
    v_add_u32 v8, 655360, v4
    v_mul_u32_u24 v5, 896, v2
    v_add_u32 v5, v5, v3
    v_lshlrev_b32 v5, 2, v5
    v_add_u32 v9, 7168, v8
    v_add_u32 v10, 7168, v9
    v_add_u32 v11, 7168, v10
    v_add_u32 v12, 7168, v11
    v_add_u32 v13, 7168, v12
    v_add_u32 v14, 7168, v13
    v_add_u32 v15, 7168, v14
    s_mov_b32 s79, 20000
    s_mov_b64 s[74:75], exec
    global_load_dwordx4 v[32:35], v8, s[42:43] offset:0 sc1
    global_load_dwordx4 v[36:39], v9, s[42:43] offset:0 sc1
    global_load_dwordx4 v[40:43], v10, s[42:43] offset:0 sc1
    global_load_dwordx4 v[44:47], v11, s[42:43] offset:0 sc1
    global_load_dwordx4 v[48:51], v12, s[42:43] offset:0 sc1
    global_load_dwordx4 v[52:55], v13, s[42:43] offset:0 sc1
    global_load_dwordx4 v[56:59], v14, s[42:43] offset:0 sc1
    global_load_dwordx4 v[60:63], v15, s[42:43] offset:0 sc1
L_pm_h2:
    s_waitcnt vmcnt(0)
    v_xor_b32 v2, s80, v34
    v_xor_b32 v3, s81, v35
    v_or_b32 v2, v2, v3
    v_cmp_ne_u32 s[44:45], 0, v2
    v_xor_b32 v2, s80, v38
    v_xor_b32 v3, s81, v39
    v_or_b32 v2, v2, v3
    v_cmp_ne_u32 s[46:47], 0, v2
    v_xor_b32 v2, s80, v42
    v_xor_b32 v3, s81, v43
    v_or_b32 v2, v2, v3
    v_cmp_ne_u32 s[48:49], 0, v2
    v_xor_b32 v2, s80, v46
    v_xor_b32 v3, s81, v47
    v_or_b32 v2, v2, v3
    v_cmp_ne_u32 s[50:51], 0, v2
    v_xor_b32 v2, s80, v50
    v_xor_b32 v3, s81, v51
    v_or_b32 v2, v2, v3
    v_cmp_ne_u32 s[52:53], 0, v2
    v_xor_b32 v2, s80, v54
    v_xor_b32 v3, s81, v55
    v_or_b32 v2, v2, v3
    v_cmp_ne_u32 s[54:55], 0, v2
    v_xor_b32 v2, s80, v58
    v_xor_b32 v3, s81, v59
    v_or_b32 v2, v2, v3
    v_cmp_ne_u32 s[68:69], 0, v2
    v_xor_b32 v2, s80, v62
    v_xor_b32 v3, s81, v63
    v_or_b32 v2, v2, v3
    v_cmp_ne_u32 s[70:71], 0, v2
    s_mov_b64 s[72:73], s[44:45]
    s_or_b64 s[72:73], s[72:73], s[46:47]
    s_or_b64 s[72:73], s[72:73], s[48:49]
    s_or_b64 s[72:73], s[72:73], s[50:51]
    s_or_b64 s[72:73], s[72:73], s[52:53]
    s_or_b64 s[72:73], s[72:73], s[54:55]
    s_or_b64 s[72:73], s[72:73], s[68:69]
    s_or_b64 s[72:73], s[72:73], s[70:71]
    s_cmp_eq_u64 s[72:73], 0
    s_cbranch_scc1 L_pmok_h2
    s_sub_u32 s79, s79, 1
    s_cmp_eq_u32 s79, 0
    s_cbranch_scc1 L_pmok_h2
    s_mov_b64 exec, s[44:45]
    s_cbranch_execz L_pmsk_h2_0
    global_load_dwordx4 v[32:35], v8, s[42:43] offset:0 sc1
L_pmsk_h2_0:
    s_mov_b64 exec, s[46:47]
    s_cbranch_execz L_pmsk_h2_1
    global_load_dwordx4 v[36:39], v9, s[42:43] offset:0 sc1
L_pmsk_h2_1:
    s_mov_b64 exec, s[48:49]
    s_cbranch_execz L_pmsk_h2_2
    global_load_dwordx4 v[40:43], v10, s[42:43] offset:0 sc1
L_pmsk_h2_2:
    s_mov_b64 exec, s[50:51]
    s_cbranch_execz L_pmsk_h2_3
    global_load_dwordx4 v[44:47], v11, s[42:43] offset:0 sc1
L_pmsk_h2_3:
    s_mov_b64 exec, s[52:53]
    s_cbranch_execz L_pmsk_h2_4
    global_load_dwordx4 v[48:51], v12, s[42:43] offset:0 sc1
L_pmsk_h2_4:
    s_mov_b64 exec, s[54:55]
    s_cbranch_execz L_pmsk_h2_5
    global_load_dwordx4 v[52:55], v13, s[42:43] offset:0 sc1
L_pmsk_h2_5:
    s_mov_b64 exec, s[68:69]
    s_cbranch_execz L_pmsk_h2_6
    global_load_dwordx4 v[56:59], v14, s[42:43] offset:0 sc1
L_pmsk_h2_6:
    s_mov_b64 exec, s[70:71]
    s_cbranch_execz L_pmsk_h2_7
    global_load_dwordx4 v[60:63], v15, s[42:43] offset:0 sc1
L_pmsk_h2_7:
    s_mov_b64 exec, s[74:75]
    s_branch L_pm_h2
L_pmok_h2:
    s_mov_b64 exec, s[74:75]
    v_pk_add_f32 v[32:33], v[32:33], v[36:37]
    v_pk_add_f32 v[32:33], v[32:33], v[40:41]
    v_pk_add_f32 v[32:33], v[32:33], v[44:45]
    v_pk_add_f32 v[32:33], v[32:33], v[48:49]
    v_pk_add_f32 v[32:33], v[32:33], v[52:53]
    v_pk_add_f32 v[32:33], v[32:33], v[56:57]
    v_pk_add_f32 v[32:33], v[32:33], v[60:61]
    ds_write_b32 v5, v32 offset:15616
    ds_write_b32 v5, v33 offset:17408
L_sv_h2_end:
    s_mov_b64 exec, s[64:65]
    s_waitcnt lgkmcnt(0)
    s_barrier
    s_cmp_ge_u32 s60, 2
    s_cbranch_scc1 L_sv_ln2_skip
    s_mul_i32 s61, s60, 1792
    v_lshl_add_u32 v4, v1, 2, s61
    ds_read_b32 v32, v4 offset:15616
    ds_read_b32 v40, v4 offset:19200
    ds_read_b32 v48, v4 offset:8448
    ds_read_b32 v8, v4 offset:22784
    ds_read_b32 v15, v4 offset:26368
    ds_read_b32 v22, v4 offset:29952
    ds_read_b32 v33, v4 offset:15872
    ds_read_b32 v41, v4 offset:19456
    ds_read_b32 v49, v4 offset:8704
    ds_read_b32 v9, v4 offset:23040
    ds_read_b32 v16, v4 offset:26624
    ds_read_b32 v23, v4 offset:30208
    ds_read_b32 v34, v4 offset:16128
    ds_read_b32 v42, v4 offset:19712
    ds_read_b32 v50, v4 offset:8960
    ds_read_b32 v10, v4 offset:23296
    ds_read_b32 v17, v4 offset:26880
    ds_read_b32 v24, v4 offset:30464
    ds_read_b32 v35, v4 offset:16384
    ds_read_b32 v43, v4 offset:19968
    ds_read_b32 v51, v4 offset:9216
    ds_read_b32 v11, v4 offset:23552
    ds_read_b32 v18, v4 offset:27136
    ds_read_b32 v25, v4 offset:30720
    ds_read_b32 v36, v4 offset:16640
    ds_read_b32 v44, v4 offset:20224
    ds_read_b32 v52, v4 offset:9472
    ds_read_b32 v12, v4 offset:23808
    ds_read_b32 v19, v4 offset:27392
    ds_read_b32 v26, v4 offset:30976
    ds_read_b32 v37, v4 offset:16896
    ds_read_b32 v45, v4 offset:20480
    ds_read_b32 v53, v4 offset:9728
    ds_read_b32 v13, v4 offset:24064
    ds_read_b32 v20, v4 offset:27648
    ds_read_b32 v27, v4 offset:31232
    ds_read_b32 v38, v4 offset:17152
    ds_read_b32 v46, v4 offset:20736
    ds_read_b32 v54, v4 offset:9984
    ds_read_b32 v14, v4 offset:24320
    ds_read_b32 v21, v4 offset:27904
    ds_read_b32 v28, v4 offset:31488
    s_waitcnt lgkmcnt(0)
    v_add_f32 v32, v32, v40
    v_cvt_pk_bf16_f32 v5, v32, v32
    v_lshlrev_b32 v32, 16, v5
    v_mul_f32 v32, v32, v8
    v_cvt_pk_bf16_f32 v5, v32, v32
    v_lshlrev_b32 v32, 16, v5
    v_add_f32 v48, v48, v32
    v_cvt_pk_bf16_f32 v5, v48, v48
    v_lshlrev_b32 v48, 16, v5
    ds_write_b32 v4, v48 offset:8448
    v_add_f32 v33, v33, v41
    v_cvt_pk_bf16_f32 v5, v33, v33
    v_lshlrev_b32 v33, 16, v5
    v_mul_f32 v33, v33, v9
    v_cvt_pk_bf16_f32 v5, v33, v33
    v_lshlrev_b32 v33, 16, v5
    v_add_f32 v49, v49, v33
    v_cvt_pk_bf16_f32 v5, v49, v49
    v_lshlrev_b32 v49, 16, v5
    ds_write_b32 v4, v49 offset:8704
    v_add_f32 v34, v34, v42
    v_cvt_pk_bf16_f32 v5, v34, v34
    v_lshlrev_b32 v34, 16, v5
    v_mul_f32 v34, v34, v10
    v_cvt_pk_bf16_f32 v5, v34, v34
    v_lshlrev_b32 v34, 16, v5
    v_add_f32 v50, v50, v34
    v_cvt_pk_bf16_f32 v5, v50, v50
    v_lshlrev_b32 v50, 16, v5
    ds_write_b32 v4, v50 offset:8960
    v_add_f32 v35, v35, v43
    v_cvt_pk_bf16_f32 v5, v35, v35
    v_lshlrev_b32 v35, 16, v5
    v_mul_f32 v35, v35, v11
    v_cvt_pk_bf16_f32 v5, v35, v35
    v_lshlrev_b32 v35, 16, v5
    v_add_f32 v51, v51, v35
    v_cvt_pk_bf16_f32 v5, v51, v51
    v_lshlrev_b32 v51, 16, v5
    ds_write_b32 v4, v51 offset:9216
    v_add_f32 v36, v36, v44
    v_cvt_pk_bf16_f32 v5, v36, v36
    v_lshlrev_b32 v36, 16, v5
    v_mul_f32 v36, v36, v12
    v_cvt_pk_bf16_f32 v5, v36, v36
    v_lshlrev_b32 v36, 16, v5
    v_add_f32 v52, v52, v36
    v_cvt_pk_bf16_f32 v5, v52, v52
    v_lshlrev_b32 v52, 16, v5
    ds_write_b32 v4, v52 offset:9472
    v_add_f32 v37, v37, v45
    v_cvt_pk_bf16_f32 v5, v37, v37
    v_lshlrev_b32 v37, 16, v5
    v_mul_f32 v37, v37, v13
    v_cvt_pk_bf16_f32 v5, v37, v37
    v_lshlrev_b32 v37, 16, v5
    v_add_f32 v53, v53, v37
    v_cvt_pk_bf16_f32 v5, v53, v53
    v_lshlrev_b32 v53, 16, v5
    ds_write_b32 v4, v53 offset:9728
    v_add_f32 v38, v38, v46
    v_cvt_pk_bf16_f32 v5, v38, v38
    v_lshlrev_b32 v38, 16, v5
    v_mul_f32 v38, v38, v14
    v_cvt_pk_bf16_f32 v5, v38, v38
    v_lshlrev_b32 v38, 16, v5
    v_add_f32 v54, v54, v38
    v_cvt_pk_bf16_f32 v5, v54, v54
    v_lshlrev_b32 v54, 16, v5
    ds_write_b32 v4, v54 offset:9984
    v_add_f32 v56, v48, v49
    v_add_f32 v56, v56, v50
    v_add_f32 v56, v56, v51
    v_add_f32 v56, v56, v52
    v_add_f32 v56, v56, v53
    v_add_f32 v56, v56, v54
    s_nop 1
    v_add_f32_dpp v56, v56, v56 quad_perm:[1,0,3,2] row_mask:0xf bank_mask:0xf
    s_nop 1
    v_add_f32_dpp v56, v56, v56 quad_perm:[2,3,0,1] row_mask:0xf bank_mask:0xf
    s_nop 1
    v_add_f32_dpp v56, v56, v56 row_half_mirror row_mask:0xf bank_mask:0xf
    s_nop 1
    v_add_f32_dpp v56, v56, v56 row_mirror row_mask:0xf bank_mask:0xf
    v_mov_b32 v57, v56
    s_nop 1
    v_permlane16_swap_b32 v56, v57
    v_add_f32 v56, v56, v57
    v_mov_b32 v57, v56
    s_nop 1
    v_permlane32_swap_b32 v56, v57
    v_add_f32 v56, v56, v57
    v_mul_f32 v56, 0x3b124925, v56
    v_sub_f32 v58, v48, v56
    v_mul_f32 v59, v58, v58
    v_sub_f32 v58, v49, v56
    v_fmac_f32 v59, v58, v58
    v_sub_f32 v58, v50, v56
    v_fmac_f32 v59, v58, v58
    v_sub_f32 v58, v51, v56
    v_fmac_f32 v59, v58, v58
    v_sub_f32 v58, v52, v56
    v_fmac_f32 v59, v58, v58
    v_sub_f32 v58, v53, v56
    v_fmac_f32 v59, v58, v58
    v_sub_f32 v58, v54, v56
    v_fmac_f32 v59, v58, v58
    s_nop 1
    v_add_f32_dpp v59, v59, v59 quad_perm:[1,0,3,2] row_mask:0xf bank_mask:0xf
    s_nop 1
    v_add_f32_dpp v59, v59, v59 quad_perm:[2,3,0,1] row_mask:0xf bank_mask:0xf
    s_nop 1
    v_add_f32_dpp v59, v59, v59 row_half_mirror row_mask:0xf bank_mask:0xf
    s_nop 1
    v_add_f32_dpp v59, v59, v59 row_mirror row_mask:0xf bank_mask:0xf
    v_mov_b32 v57, v59
    s_nop 1
    v_permlane16_swap_b32 v59, v57
    v_add_f32 v59, v59, v57
    v_mov_b32 v57, v59
    s_nop 1
    v_permlane32_swap_b32 v59, v57
    v_add_f32 v59, v59, v57
    v_mul_f32 v59, 0x3b124925, v59
    v_cvt_pk_bf16_f32 v57, v56, v56
    v_lshlrev_b32 v56, 16, v57
    v_cvt_pk_bf16_f32 v57, v59, v59
    v_lshlrev_b32 v59, 16, v57
    v_add_f32 v59, 0x3727c5ac, v59
    v_cvt_pk_bf16_f32 v57, v59, v59
    v_lshlrev_b32 v59, 16, v57
    v_sqrt_f32 v59, v59
    s_nop 0
    v_cvt_pk_bf16_f32 v57, v59, v59
    v_lshlrev_b32 v59, 16, v57
    v_rcp_f32 v60, v59
    s_nop 0
    s_mul_i32 s61, s60, 896
    v_lshl_add_u32 v4, v1, 1, s61
    v_sub_f32 v34, v48, v56
    v_cvt_pk_bf16_f32 v35, v34, v34
    v_lshlrev_b32 v34, 16, v35
    v_mul_f32 v32, v34, v60
    v_fma_f32 v35, -v32, v59, v34
    v_fmac_f32 v32, v35, v60
    v_cvt_pk_bf16_f32 v35, v32, v32
    v_lshlrev_b32 v32, 16, v35
    v_add_f32 v22, 1.0, v22
    v_cvt_pk_bf16_f32 v34, v22, v22
    v_lshlrev_b32 v22, 16, v34
    v_mul_f32 v32, v32, v22
    v_cvt_pk_bf16_f32 v34, v32, v32
    v_lshlrev_b32 v32, 16, v34
    v_add_f32 v32, v32, v15
    v_cvt_pk_bf16_f32 v32, v32, v32
    ds_write_b16 v4, v32 offset:41728
    v_sub_f32 v34, v49, v56
    v_cvt_pk_bf16_f32 v35, v34, v34
    v_lshlrev_b32 v34, 16, v35
    v_mul_f32 v32, v34, v60
    v_fma_f32 v35, -v32, v59, v34
    v_fmac_f32 v32, v35, v60
    v_cvt_pk_bf16_f32 v35, v32, v32
    v_lshlrev_b32 v32, 16, v35
    v_add_f32 v23, 1.0, v23
    v_cvt_pk_bf16_f32 v34, v23, v23
    v_lshlrev_b32 v23, 16, v34
    v_mul_f32 v32, v32, v23
    v_cvt_pk_bf16_f32 v34, v32, v32
    v_lshlrev_b32 v32, 16, v34
    v_add_f32 v32, v32, v16
    v_cvt_pk_bf16_f32 v32, v32, v32
    ds_write_b16 v4, v32 offset:41856
    v_sub_f32 v34, v50, v56
    v_cvt_pk_bf16_f32 v35, v34, v34
    v_lshlrev_b32 v34, 16, v35
    v_mul_f32 v32, v34, v60
    v_fma_f32 v35, -v32, v59, v34
    v_fmac_f32 v32, v35, v60
    v_cvt_pk_bf16_f32 v35, v32, v32
    v_lshlrev_b32 v32, 16, v35
    v_add_f32 v24, 1.0, v24
    v_cvt_pk_bf16_f32 v34, v24, v24
    v_lshlrev_b32 v24, 16, v34
    v_mul_f32 v32, v32, v24
    v_cvt_pk_bf16_f32 v34, v32, v32
    v_lshlrev_b32 v32, 16, v34
    v_add_f32 v32, v32, v17
    v_cvt_pk_bf16_f32 v32, v32, v32
    ds_write_b16 v4, v32 offset:41984
    v_sub_f32 v34, v51, v56
    v_cvt_pk_bf16_f32 v35, v34, v34
    v_lshlrev_b32 v34, 16, v35
    v_mul_f32 v32, v34, v60
    v_fma_f32 v35, -v32, v59, v34
    v_fmac_f32 v32, v35, v60
    v_cvt_pk_bf16_f32 v35, v32, v32
    v_lshlrev_b32 v32, 16, v35
    v_add_f32 v25, 1.0, v25
    v_cvt_pk_bf16_f32 v34, v25, v25
    v_lshlrev_b32 v25, 16, v34
    v_mul_f32 v32, v32, v25
    v_cvt_pk_bf16_f32 v34, v32, v32
    v_lshlrev_b32 v32, 16, v34
    v_add_f32 v32, v32, v18
    v_cvt_pk_bf16_f32 v32, v32, v32
    ds_write_b16 v4, v32 offset:42112
    v_sub_f32 v34, v52, v56
    v_cvt_pk_bf16_f32 v35, v34, v34
    v_lshlrev_b32 v34, 16, v35
    v_mul_f32 v32, v34, v60
    v_fma_f32 v35, -v32, v59, v34
    v_fmac_f32 v32, v35, v60
    v_cvt_pk_bf16_f32 v35, v32, v32
    v_lshlrev_b32 v32, 16, v35
    v_add_f32 v26, 1.0, v26
    v_cvt_pk_bf16_f32 v34, v26, v26
    v_lshlrev_b32 v26, 16, v34
    v_mul_f32 v32, v32, v26
    v_cvt_pk_bf16_f32 v34, v32, v32
    v_lshlrev_b32 v32, 16, v34
    v_add_f32 v32, v32, v19
    v_cvt_pk_bf16_f32 v32, v32, v32
    ds_write_b16 v4, v32 offset:42240
    v_sub_f32 v34, v53, v56
    v_cvt_pk_bf16_f32 v35, v34, v34
    v_lshlrev_b32 v34, 16, v35
    v_mul_f32 v32, v34, v60
    v_fma_f32 v35, -v32, v59, v34
    v_fmac_f32 v32, v35, v60
    v_cvt_pk_bf16_f32 v35, v32, v32
    v_lshlrev_b32 v32, 16, v35
    v_add_f32 v27, 1.0, v27
    v_cvt_pk_bf16_f32 v34, v27, v27
    v_lshlrev_b32 v27, 16, v34
    v_mul_f32 v32, v32, v27
    v_cvt_pk_bf16_f32 v34, v32, v32
    v_lshlrev_b32 v32, 16, v34
    v_add_f32 v32, v32, v20
    v_cvt_pk_bf16_f32 v32, v32, v32
    ds_write_b16 v4, v32 offset:42368
    v_sub_f32 v34, v54, v56
    v_cvt_pk_bf16_f32 v35, v34, v34
    v_lshlrev_b32 v34, 16, v35
    v_mul_f32 v32, v34, v60
    v_fma_f32 v35, -v32, v59, v34
    v_fmac_f32 v32, v35, v60
    v_cvt_pk_bf16_f32 v35, v32, v32
    v_lshlrev_b32 v32, 16, v35
    v_add_f32 v28, 1.0, v28
    v_cvt_pk_bf16_f32 v34, v28, v28
    v_lshlrev_b32 v28, 16, v34
    v_mul_f32 v32, v32, v28
    v_cvt_pk_bf16_f32 v34, v32, v32
    v_lshlrev_b32 v32, 16, v34
    v_add_f32 v32, v32, v21
    v_cvt_pk_bf16_f32 v32, v32, v32
    ds_write_b16 v4, v32 offset:42496
L_sv_ln2_skip:
    s_waitcnt lgkmcnt(0)
    s_barrier
    v_and_b32 v2, 1, v0
    v_mul_u32_u24 v2, 896, v2
    v_bfe_u32 v3, v0, 4, 2
    v_lshl_add_u32 v2, v3, 4, v2
    s_lshr_b32 s61, s60, 3
    s_mul_i32 s61, s61, 448
    v_add_u32 v2, s61, v2
    ds_read_b128 v[32:35], v2 offset:41728
    ds_read_b128 v[36:39], v2 offset:41792
    ds_read_b128 v[40:43], v2 offset:41856
    ds_read_b128 v[44:47], v2 offset:41920
    ds_read_b128 v[48:51], v2 offset:41984
    ds_read_b128 v[52:55], v2 offset:42048
    ds_read_b128 v[56:59], v2 offset:42112
    v_mov_b32 v8, 0
    v_mov_b32 v9, 0
    v_mov_b32 v10, 0
    v_mov_b32 v11, 0
    s_nop 1
    s_waitcnt lgkmcnt(6)
    v_mfma_f32_16x16x32_bf16 v[8:11], v[32:35], v[64:67], v[8:11]
    s_waitcnt lgkmcnt(5)
    v_mfma_f32_16x16x32_bf16 v[8:11], v[36:39], v[68:71], v[8:11]
    s_waitcnt lgkmcnt(4)
    v_mfma_f32_16x16x32_bf16 v[8:11], v[40:43], v[72:75], v[8:11]
    s_waitcnt lgkmcnt(3)
    v_mfma_f32_16x16x32_bf16 v[8:11], v[44:47], v[76:79], v[8:11]
    s_waitcnt lgkmcnt(2)
    v_mfma_f32_16x16x32_bf16 v[8:11], v[48:51], v[80:83], v[8:11]
    s_waitcnt lgkmcnt(1)
    v_mfma_f32_16x16x32_bf16 v[8:11], v[52:55], v[84:87], v[8:11]
    s_waitcnt lgkmcnt(0)
    v_mfma_f32_16x16x32_bf16 v[8:11], v[56:59], v[88:91], v[8:11]
    s_lshl_b32 s61, s60, 7
    v_lshl_add_u32 v2, v1, 2, s61
    v_cmp_gt_u32 vcc, 16, v1
    s_and_saveexec_b64 s[64:65], vcc
    s_nop 5
    ds_write_b32 v2, v8 offset:43776
    ds_write_b32 v2, v9 offset:43840
    s_mov_b64 exec, s[64:65]
    s_waitcnt lgkmcnt(0)
    s_barrier
    v_cmp_gt_u32 vcc, 128, v0
    s_and_saveexec_b64 s[64:65], vcc
    s_cbranch_execz L_sv_act_end
    v_bfe_u32 v2, v0, 4, 2
    v_lshlrev_b32 v2, 5, v2
    v_lshrrev_b32 v3, 6, v0
    v_lshl_add_u32 v2, v3, 4, v2
    v_and_b32 v4, 15, v0
    v_add_u32 v2, v2, v4
    v_lshlrev_b32 v2, 2, v2
    ds_read_b32 v32, v2 offset:43776
    ds_read_b32 v33, v2 offset:44800
    ds_read_b32 v64, v2 offset:44288
    ds_read_b32 v65, v2 offset:45312
    s_waitcnt lgkmcnt(0)
    v_add_f32 v32, v32, v33
    v_add_f32 v64, v64, v65
    v_cvt_pk_bf16_f32 v9, v32, v32
    v_lshlrev_b32 v32, 16, v9
    v_cvt_pk_bf16_f32 v9, v64, v64
    v_lshlrev_b32 v64, 16, v9
    v_mul_f32 v9, v32, v32
    v_mul_f32 v9, v9, v32
    v_mov_b32 v10, 0x3d372713
    v_fma_f32 v9, v9, v10, v32
    v_mul_f32 v9, 0x40135761, v9
    v_exp_f32 v9, v9
    s_nop 0
    v_add_f32 v9, 1.0, v9
    v_rcp_f32 v9, v9
    s_nop 0
    v_fma_f32 v9, v9, -2.0, 1.0
    v_add_f32 v9, 1.0, v9
    v_mul_f32 v9, 0.5, v9
    v_mul_f32 v9, v9, v32
    v_cvt_pk_bf16_f32 v10, v9, v9
    v_lshlrev_b32 v9, 16, v10
    v_mul_f32 v32, v9, v64
    v_cvt_pk_bf16_f32 v32, v32, v32
    v_lshlrev_b32 v2, 1, v0
    ds_write_b16 v2, v32 offset:43520
L_sv_act_end:
    s_mov_b64 exec, s[64:65]
    s_waitcnt lgkmcnt(0)
    s_barrier
    v_and_b32 v2, 1, v0
    v_lshlrev_b32 v2, 7, v2
    v_bfe_u32 v3, v0, 4, 2
    v_lshl_add_u32 v2, v3, 4, v2
    ds_read_b128 v[32:35], v2 offset:43520
    ds_read_b128 v[36:39], v2 offset:43584
    v_mov_b32 v8, 0
    v_mov_b32 v9, 0
    v_mov_b32 v10, 0
    v_mov_b32 v11, 0
    v_mov_b32 v12, 0
    v_mov_b32 v13, 0
    v_mov_b32 v14, 0
    v_mov_b32 v15, 0
    s_nop 1
    s_waitcnt lgkmcnt(0)
    v_mfma_f32_16x16x32_bf16 v[8:11], v[32:35], v[112:115], v[8:11]
    v_mfma_f32_16x16x32_bf16 v[12:15], v[32:35], v[120:123], v[12:15]
    v_mfma_f32_16x16x32_bf16 v[8:11], v[36:39], v[116:119], v[8:11]
    v_mfma_f32_16x16x32_bf16 v[12:15], v[36:39], v[124:127], v[12:15]
    s_mul_i32 s61, s2, 448
    s_lshl_b32 s62, s60, 4
    s_add_u32 s61, s61, s62
    v_add_u32 v2, s61, v1
    v_lshlrev_b32 v2, 4, v2
    v_add_u32 v2, 786432, v2
    v_cmp_gt_u32 vcc, 16, v1
    s_and_saveexec_b64 s[64:65], vcc
    s_nop 4
    v_mov_b32 v10, s80
    v_mov_b32 v11, s81
    v_mov_b32 v14, s80
    v_mov_b32 v15, s81
    global_store_dwordx4 v2, v[8:11], s[42:43] sc1
    s_cmp_ge_u32 s60, 12
    s_cbranch_scc1 L_sv_dn_not1
    v_add_u32 v2, 4096, v2
    global_store_dwordx4 v2, v[12:15], s[42:43] sc1
L_sv_dn_not1:
    s_mov_b64 exec, s[64:65]
    v_cmp_gt_u32 vcc, 448, v0
    s_and_saveexec_b64 s[64:65], vcc
    s_cbranch_execz L_sv_dnp_end
    v_lshrrev_b32 v2, 4, v0
    v_mul_u32_u24 v2, 448, v2
    v_and_b32 v3, 15, v0
    v_add_u32 v2, v2, v3
    s_lshl_b32 s61, s2, 4
    v_add_u32 v2, s61, v2
    v_lshlrev_b32 v2, 4, v2
    v_add_u32 v2, 786432, v2
    s_mov_b32 s79, 20000
L_poll_dn:
    global_load_dwordx4 v[32:35], v2, s[42:43] offset:0 sc1
    s_waitcnt vmcnt(0)
    v_xor_b32 v4, s80, v34
    v_xor_b32 v5, s81, v35
    v_or_b32 v4, v4, v5
    v_cmp_ne_u32 vcc, 0, v4
    s_cbranch_vccz L_pollok_dn
    s_sleep 0
    s_sub_u32 s79, s79, 1
    s_cmp_lg_u32 s79, 0
    s_cbranch_scc1 L_poll_dn
L_pollok_dn:
    v_lshlrev_b32 v4, 3, v0
    ds_write_b64 v4, v[32:33] offset:37120
L_sv_dnp_end:
    s_mov_b64 exec, s[64:65]
    s_waitcnt lgkmcnt(0)
    s_barrier
    v_cmp_gt_u32 vcc, 32, v0
    s_and_saveexec_b64 s[64:65], vcc
    s_cbranch_execz L_sv_dn_end
    v_and_b32 v5, 15, v0
    v_lshlrev_b32 v4, 3, v5
    v_lshrrev_b32 v6, 4, v0
    v_lshl_add_u32 v4, v6, 2, v4
    ds_read_b32 v32, v4 offset:37120
    ds_read_b32 v33, v4 offset:37248
    ds_read_b32 v34, v4 offset:37376
    ds_read_b32 v35, v4 offset:37504
    ds_read_b32 v36, v4 offset:37632
    ds_read_b32 v37, v4 offset:37760
    ds_read_b32 v38, v4 offset:37888
    ds_read_b32 v39, v4 offset:38016
    ds_read_b32 v40, v4 offset:38144
    ds_read_b32 v41, v4 offset:38272
    ds_read_b32 v42, v4 offset:38400
    ds_read_b32 v43, v4 offset:38528
    ds_read_b32 v44, v4 offset:38656
    ds_read_b32 v45, v4 offset:38784
    ds_read_b32 v46, v4 offset:38912
    ds_read_b32 v47, v4 offset:39040
    ds_read_b32 v48, v4 offset:39168
    ds_read_b32 v49, v4 offset:39296
    ds_read_b32 v50, v4 offset:39424
    ds_read_b32 v51, v4 offset:39552
    ds_read_b32 v52, v4 offset:39680
    ds_read_b32 v53, v4 offset:39808
    ds_read_b32 v54, v4 offset:39936
    ds_read_b32 v55, v4 offset:40064
    ds_read_b32 v56, v4 offset:40192
    ds_read_b32 v57, v4 offset:40320
    ds_read_b32 v58, v4 offset:40448
    ds_read_b32 v59, v4 offset:40576
    s_lshl_b32 s61, s2, 4
    v_add_u32 v5, s61, v5
    v_mul_u32_u24 v6, 448, v6
    v_add_u32 v5, v5, v6
    v_lshlrev_b32 v6, 2, v5
    v_add_u32 v7, 33536, v6
    ds_read_b32 v30, v6 offset:8448
    ds_read_b32 v31, v7
    s_waitcnt lgkmcnt(0)
    v_add_f32 v32, v32, v33
    v_add_f32 v32, v32, v34
    v_add_f32 v32, v32, v35
    v_add_f32 v32, v32, v36
    v_add_f32 v32, v32, v37
    v_add_f32 v32, v32, v38
    v_add_f32 v32, v32, v39
    v_add_f32 v32, v32, v40
    v_add_f32 v32, v32, v41
    v_add_f32 v32, v32, v42
    v_add_f32 v32, v32, v43
    v_add_f32 v32, v32, v44
    v_add_f32 v32, v32, v45
    v_add_f32 v32, v32, v46
    v_add_f32 v32, v32, v47
    v_add_f32 v32, v32, v48
    v_add_f32 v32, v32, v49
    v_add_f32 v32, v32, v50
    v_add_f32 v32, v32, v51
    v_add_f32 v32, v32, v52
    v_add_f32 v32, v32, v53
    v_add_f32 v32, v32, v54
    v_add_f32 v32, v32, v55
    v_add_f32 v32, v32, v56
    v_add_f32 v32, v32, v57
    v_add_f32 v32, v32, v58
    v_add_f32 v32, v32, v59
    v_cvt_pk_bf16_f32 v9, v32, v32
    v_lshlrev_b32 v32, 16, v9
    v_mul_f32 v32, v32, v31
    v_cvt_pk_bf16_f32 v9, v32, v32
    v_lshlrev_b32 v32, 16, v9
    v_add_f32 v32, v32, v30
    v_cvt_pk_bf16_f32 v32, v32, v32
    v_lshlrev_b32 v5, 1, v5
    global_store_short v5, v32, s[38:39]
L_sv_dn_end:
    s_mov_b64 exec, s[64:65]
L_sv_exit:
    s_endpgm
L_stream:
    s_sub_u32 s56, s2, 32
    s_mul_hi_u32 s57, s56, 0x24924925
    s_mul_i32 s58, s57, 7
    s_sub_u32 s58, s56, s58
    s_lshl_b32 s59, s57, 21
    s_mul_i32 s61, s58, 300032
    v_lshlrev_b32 v1, 4, v0
    v_add_u32 v1, s61, v1
    s_add_u32 s66, s61, 300032
    s_min_u32 s66, s66, 0x200000
    v_lshrrev_b32 v2, 6, v0
    s_nop 0
    v_readfirstlane_b32 s67, v2
    s_waitcnt lgkmcnt(0)
    s_add_u32 s44, s18, s59
    s_addc_u32 s45, s19, 0
    s_and_b32 s45, s45, 0xffff
    s_mov_b32 s46, s66
    s_mov_b32 s47, 0x00020000
    s_add_u32 s48, s20, s59
    s_addc_u32 s49, s21, 0
    s_and_b32 s49, s49, 0xffff
    s_mov_b32 s50, s66
    s_mov_b32 s51, 0x00020000
    s_mov_b32 s60, 0
    buffer_load_dwordx4 v[32:35], v1, s[44:47], s60 offen nt
    s_add_u32 s60, s60, 16384
    buffer_load_dwordx4 v[36:39], v1, s[44:47], s60 offen nt
    s_add_u32 s60, s60, 16384
    buffer_load_dwordx4 v[40:43], v1, s[44:47], s60 offen nt
    s_add_u32 s60, s60, 16384
    buffer_load_dwordx4 v[44:47], v1, s[44:47], s60 offen nt
    s_add_u32 s60, s60, 16384
    buffer_load_dwordx4 v[48:51], v1, s[44:47], s60 offen nt
    s_add_u32 s60, s60, 16384
    buffer_load_dwordx4 v[52:55], v1, s[44:47], s60 offen nt
    s_add_u32 s60, s60, 16384
    buffer_load_dwordx4 v[56:59], v1, s[44:47], s60 offen nt
    s_add_u32 s60, s60, 16384
    buffer_load_dwordx4 v[60:63], v1, s[44:47], s60 offen nt
    s_add_u32 s60, s60, 16384
    buffer_load_dwordx4 v[64:67], v1, s[44:47], s60 offen nt
    s_add_u32 s60, s60, 16384
    buffer_load_dwordx4 v[68:71], v1, s[44:47], s60 offen nt
    s_add_u32 s60, s60, 16384
    buffer_load_dwordx4 v[72:75], v1, s[44:47], s60 offen nt
    s_add_u32 s60, s60, 16384
    buffer_load_dwordx4 v[76:79], v1, s[44:47], s60 offen nt
    s_add_u32 s60, s60, 16384
    buffer_load_dwordx4 v[80:83], v1, s[44:47], s60 offen nt
    s_add_u32 s60, s60, 16384
    buffer_load_dwordx4 v[84:87], v1, s[44:47], s60 offen nt
    s_add_u32 s60, s60, 16384
    buffer_load_dwordx4 v[88:91], v1, s[44:47], s60 offen nt
    s_add_u32 s60, s60, 16384
    buffer_load_dwordx4 v[92:95], v1, s[44:47], s60 offen nt
    s_add_u32 s60, s60, 16384
    buffer_load_dwordx4 v[96:99], v1, s[44:47], s60 offen nt
    s_add_u32 s60, s60, 16384
    buffer_load_dwordx4 v[100:103], v1, s[44:47], s60 offen nt
    s_add_u32 s60, s60, 16384
    buffer_load_dwordx4 v[104:107], v1, s[44:47], s60 offen nt
    v_and_b32 v2, 31, v0
    v_lshlrev_b32 v2, 5, v2
    s_lshl_b32 s61, s57, 10
    v_add_u32 v2, s61, v2
    v_add_u32 v3, 32768, v2
    v_mov_b32 v31, 0
    s_mov_b32 s60, 0
    s_waitcnt vmcnt(3)
    global_load_dwordx2 v[12:13], v31, s[40:41] sc1
    global_load_dwordx4 v[4:7], v3, s[42:43] sc1
    global_load_dwordx4 v[8:11], v3, s[42:43] offset:16 sc1
    buffer_load_dwordx4 v[108:111], v1, s[48:51], s60 offen nt
    s_add_u32 s60, s60, 16384
    buffer_load_dwordx4 v[112:115], v1, s[48:51], s60 offen nt
    s_add_u32 s60, s60, 16384
    buffer_load_dwordx4 v[116:119], v1, s[48:51], s60 offen nt
    s_add_u32 s60, s60, 16384
    buffer_load_dwordx4 v[120:123], v1, s[48:51], s60 offen nt
    s_add_u32 s60, s60, 16384
    buffer_load_dwordx4 v[124:127], v1, s[48:51], s60 offen nt
    s_add_u32 s60, s60, 16384
    v_lshrrev_b32 v2, 6, v0
    s_nop 0
    v_readfirstlane_b32 s64, v2
    s_mul_i32 s64, s64, 0
    s_add_u32 s64, s64, 18432
    s_mov_b32 s79, 20000
    s_waitcnt vmcnt(5)
L_st_chk:
    v_xor_b32 v14, v12, v6
    v_xor_b32 v15, v13, v7
    v_xor_b32 v16, v12, v10
    v_xor_b32 v17, v13, v11
    v_or3_b32 v14, v14, v15, v16
    v_or_b32 v14, v14, v17
    v_cmp_eq_u32 s[62:63], 0, v12
    v_cmp_ne_u32 vcc, 0, v14
    s_or_b64 vcc, vcc, s[62:63]
    s_cbranch_vccz L_st_ok
    s_sub_u32 s79, s79, 1
    s_cmp_eq_u32 s79, 0
    s_cbranch_scc1 L_st_ok
    s_sleep 4
    global_load_dwordx2 v[12:13], v31, s[40:41] sc1
    global_load_dwordx4 v[4:7], v3, s[42:43] sc1
    global_load_dwordx4 v[8:11], v3, s[42:43] offset:16 sc1
    s_waitcnt vmcnt(0)
    s_branch L_st_chk
L_st_ok:
    v_readfirstlane_b32 s80, v12
    v_readfirstlane_b32 s81, v13
    v_dot2_f32_bf16 v12, v32, v4, 0
    v_dot2_f32_bf16 v12, v33, v5, v12
    v_dot2_f32_bf16 v12, v34, v8, v12
    v_dot2_f32_bf16 v12, v35, v9, v12
    buffer_load_dwordx4 v[32:35], v1, s[48:51], s60 offen nt
    s_add_u32 s60, s60, 16384
    v_dot2_f32_bf16 v13, v36, v4, 0
    v_dot2_f32_bf16 v13, v37, v5, v13
    v_dot2_f32_bf16 v13, v38, v8, v13
    v_dot2_f32_bf16 v13, v39, v9, v13
    buffer_load_dwordx4 v[36:39], v1, s[48:51], s60 offen nt
    s_add_u32 s60, s60, 16384
    v_dot2_f32_bf16 v14, v40, v4, 0
    v_dot2_f32_bf16 v14, v41, v5, v14
    v_dot2_f32_bf16 v14, v42, v8, v14
    v_dot2_f32_bf16 v14, v43, v9, v14
    buffer_load_dwordx4 v[40:43], v1, s[48:51], s60 offen nt
    s_add_u32 s60, s60, 16384
    v_dot2_f32_bf16 v15, v44, v4, 0
    v_dot2_f32_bf16 v15, v45, v5, v15
    v_dot2_f32_bf16 v15, v46, v8, v15
    v_dot2_f32_bf16 v15, v47, v9, v15
    buffer_load_dwordx4 v[44:47], v1, s[48:51], s60 offen nt
    s_add_u32 s60, s60, 16384
    v_dot2_f32_bf16 v16, v48, v4, 0
    v_dot2_f32_bf16 v16, v49, v5, v16
    v_dot2_f32_bf16 v16, v50, v8, v16
    v_dot2_f32_bf16 v16, v51, v9, v16
    buffer_load_dwordx4 v[48:51], v1, s[48:51], s60 offen nt
    s_add_u32 s60, s60, 16384
    v_dot2_f32_bf16 v17, v52, v4, 0
    v_dot2_f32_bf16 v17, v53, v5, v17
    v_dot2_f32_bf16 v17, v54, v8, v17
    v_dot2_f32_bf16 v17, v55, v9, v17
    buffer_load_dwordx4 v[52:55], v1, s[48:51], s60 offen nt
    s_add_u32 s60, s60, 16384
    v_dot2_f32_bf16 v18, v56, v4, 0
    v_dot2_f32_bf16 v18, v57, v5, v18
    v_dot2_f32_bf16 v18, v58, v8, v18
    v_dot2_f32_bf16 v18, v59, v9, v18
    buffer_load_dwordx4 v[56:59], v1, s[48:51], s60 offen nt
    s_add_u32 s60, s60, 16384
    v_dot2_f32_bf16 v19, v60, v4, 0
    v_dot2_f32_bf16 v19, v61, v5, v19
    v_dot2_f32_bf16 v19, v62, v8, v19
    v_dot2_f32_bf16 v19, v63, v9, v19
    buffer_load_dwordx4 v[60:63], v1, s[48:51], s60 offen nt
    s_add_u32 s60, s60, 16384
    v_dot2_f32_bf16 v20, v64, v4, 0
    v_dot2_f32_bf16 v20, v65, v5, v20
    v_dot2_f32_bf16 v20, v66, v8, v20
    v_dot2_f32_bf16 v20, v67, v9, v20
    buffer_load_dwordx4 v[64:67], v1, s[48:51], s60 offen nt
    s_add_u32 s60, s60, 16384
    v_dot2_f32_bf16 v21, v68, v4, 0
    v_dot2_f32_bf16 v21, v69, v5, v21
    v_dot2_f32_bf16 v21, v70, v8, v21
    v_dot2_f32_bf16 v21, v71, v9, v21
    buffer_load_dwordx4 v[68:71], v1, s[48:51], s60 offen nt
    s_add_u32 s60, s60, 16384
    v_dot2_f32_bf16 v22, v72, v4, 0
    v_dot2_f32_bf16 v22, v73, v5, v22
    v_dot2_f32_bf16 v22, v74, v8, v22
    v_dot2_f32_bf16 v22, v75, v9, v22
    buffer_load_dwordx4 v[72:75], v1, s[48:51], s60 offen nt
    s_add_u32 s60, s60, 16384
    v_dot2_f32_bf16 v23, v76, v4, 0
    v_dot2_f32_bf16 v23, v77, v5, v23
    v_dot2_f32_bf16 v23, v78, v8, v23
    v_dot2_f32_bf16 v23, v79, v9, v23
    buffer_load_dwordx4 v[76:79], v1, s[48:51], s60 offen nt
    s_add_u32 s60, s60, 16384
    v_dot2_f32_bf16 v24, v80, v4, 0
    v_dot2_f32_bf16 v24, v81, v5, v24
    v_dot2_f32_bf16 v24, v82, v8, v24
    v_dot2_f32_bf16 v24, v83, v9, v24
    buffer_load_dwordx4 v[80:83], v1, s[48:51], s60 offen nt
    s_add_u32 s60, s60, 16384
    v_dot2_f32_bf16 v25, v84, v4, 0
    v_dot2_f32_bf16 v25, v85, v5, v25
    v_dot2_f32_bf16 v25, v86, v8, v25
    v_dot2_f32_bf16 v25, v87, v9, v25
    buffer_load_dwordx4 v[84:87], v1, s[48:51], s60 offen nt
    s_add_u32 s60, s60, 16384
    v_dot2_f32_bf16 v26, v88, v4, 0
    v_dot2_f32_bf16 v26, v89, v5, v26
    v_dot2_f32_bf16 v26, v90, v8, v26
    v_dot2_f32_bf16 v26, v91, v9, v26
    v_dot2_f32_bf16 v27, v92, v4, 0
    v_dot2_f32_bf16 v27, v93, v5, v27
    v_dot2_f32_bf16 v27, v94, v8, v27
    v_dot2_f32_bf16 v27, v95, v9, v27
    v_dot2_f32_bf16 v28, v96, v4, 0
    v_dot2_f32_bf16 v28, v97, v5, v28
    v_dot2_f32_bf16 v28, v98, v8, v28
    v_dot2_f32_bf16 v28, v99, v9, v28
    v_dot2_f32_bf16 v29, v100, v4, 0
    v_dot2_f32_bf16 v29, v101, v5, v29
    v_dot2_f32_bf16 v29, v102, v8, v29
    v_dot2_f32_bf16 v29, v103, v9, v29
    v_dot2_f32_bf16 v30, v104, v4, 0
    v_dot2_f32_bf16 v30, v105, v5, v30
    v_dot2_f32_bf16 v30, v106, v8, v30
    v_dot2_f32_bf16 v30, v107, v9, v30
    s_nop 1
    v_add_f32_dpp v12, v12, v12 quad_perm:[1,0,3,2] row_mask:0xf bank_mask:0xf
    v_add_f32_dpp v13, v13, v13 quad_perm:[1,0,3,2] row_mask:0xf bank_mask:0xf
    v_add_f32_dpp v14, v14, v14 quad_perm:[1,0,3,2] row_mask:0xf bank_mask:0xf
    v_add_f32_dpp v15, v15, v15 quad_perm:[1,0,3,2] row_mask:0xf bank_mask:0xf
    v_add_f32_dpp v16, v16, v16 quad_perm:[1,0,3,2] row_mask:0xf bank_mask:0xf
    v_add_f32_dpp v17, v17, v17 quad_perm:[1,0,3,2] row_mask:0xf bank_mask:0xf
    v_add_f32_dpp v18, v18, v18 quad_perm:[1,0,3,2] row_mask:0xf bank_mask:0xf
    v_add_f32_dpp v19, v19, v19 quad_perm:[1,0,3,2] row_mask:0xf bank_mask:0xf
    v_add_f32_dpp v20, v20, v20 quad_perm:[1,0,3,2] row_mask:0xf bank_mask:0xf
    v_add_f32_dpp v21, v21, v21 quad_perm:[1,0,3,2] row_mask:0xf bank_mask:0xf
    v_add_f32_dpp v22, v22, v22 quad_perm:[1,0,3,2] row_mask:0xf bank_mask:0xf
    v_add_f32_dpp v23, v23, v23 quad_perm:[1,0,3,2] row_mask:0xf bank_mask:0xf
    v_add_f32_dpp v24, v24, v24 quad_perm:[1,0,3,2] row_mask:0xf bank_mask:0xf
    v_add_f32_dpp v25, v25, v25 quad_perm:[1,0,3,2] row_mask:0xf bank_mask:0xf
    v_add_f32_dpp v26, v26, v26 quad_perm:[1,0,3,2] row_mask:0xf bank_mask:0xf
    v_add_f32_dpp v27, v27, v27 quad_perm:[1,0,3,2] row_mask:0xf bank_mask:0xf
    v_add_f32_dpp v28, v28, v28 quad_perm:[1,0,3,2] row_mask:0xf bank_mask:0xf
    v_add_f32_dpp v29, v29, v29 quad_perm:[1,0,3,2] row_mask:0xf bank_mask:0xf
    v_add_f32_dpp v30, v30, v30 quad_perm:[1,0,3,2] row_mask:0xf bank_mask:0xf
    s_nop 1
    v_add_f32_dpp v12, v12, v12 quad_perm:[2,3,0,1] row_mask:0xf bank_mask:0xf
    v_add_f32_dpp v13, v13, v13 quad_perm:[2,3,0,1] row_mask:0xf bank_mask:0xf
    v_add_f32_dpp v14, v14, v14 quad_perm:[2,3,0,1] row_mask:0xf bank_mask:0xf
    v_add_f32_dpp v15, v15, v15 quad_perm:[2,3,0,1] row_mask:0xf bank_mask:0xf
    v_add_f32_dpp v16, v16, v16 quad_perm:[2,3,0,1] row_mask:0xf bank_mask:0xf
    v_add_f32_dpp v17, v17, v17 quad_perm:[2,3,0,1] row_mask:0xf bank_mask:0xf
    v_add_f32_dpp v18, v18, v18 quad_perm:[2,3,0,1] row_mask:0xf bank_mask:0xf
    v_add_f32_dpp v19, v19, v19 quad_perm:[2,3,0,1] row_mask:0xf bank_mask:0xf
    v_add_f32_dpp v20, v20, v20 quad_perm:[2,3,0,1] row_mask:0xf bank_mask:0xf
    v_add_f32_dpp v21, v21, v21 quad_perm:[2,3,0,1] row_mask:0xf bank_mask:0xf
    v_add_f32_dpp v22, v22, v22 quad_perm:[2,3,0,1] row_mask:0xf bank_mask:0xf
    v_add_f32_dpp v23, v23, v23 quad_perm:[2,3,0,1] row_mask:0xf bank_mask:0xf
    v_add_f32_dpp v24, v24, v24 quad_perm:[2,3,0,1] row_mask:0xf bank_mask:0xf
    v_add_f32_dpp v25, v25, v25 quad_perm:[2,3,0,1] row_mask:0xf bank_mask:0xf
    v_add_f32_dpp v26, v26, v26 quad_perm:[2,3,0,1] row_mask:0xf bank_mask:0xf
    v_add_f32_dpp v27, v27, v27 quad_perm:[2,3,0,1] row_mask:0xf bank_mask:0xf
    v_add_f32_dpp v28, v28, v28 quad_perm:[2,3,0,1] row_mask:0xf bank_mask:0xf
    v_add_f32_dpp v29, v29, v29 quad_perm:[2,3,0,1] row_mask:0xf bank_mask:0xf
    v_add_f32_dpp v30, v30, v30 quad_perm:[2,3,0,1] row_mask:0xf bank_mask:0xf
    s_nop 1
    v_add_f32_dpp v12, v12, v12 row_half_mirror row_mask:0xf bank_mask:0xf
    v_add_f32_dpp v13, v13, v13 row_half_mirror row_mask:0xf bank_mask:0xf
    v_add_f32_dpp v14, v14, v14 row_half_mirror row_mask:0xf bank_mask:0xf
    v_add_f32_dpp v15, v15, v15 row_half_mirror row_mask:0xf bank_mask:0xf
    v_add_f32_dpp v16, v16, v16 row_half_mirror row_mask:0xf bank_mask:0xf
    v_add_f32_dpp v17, v17, v17 row_half_mirror row_mask:0xf bank_mask:0xf
    v_add_f32_dpp v18, v18, v18 row_half_mirror row_mask:0xf bank_mask:0xf
    v_add_f32_dpp v19, v19, v19 row_half_mirror row_mask:0xf bank_mask:0xf
    v_add_f32_dpp v20, v20, v20 row_half_mirror row_mask:0xf bank_mask:0xf
    v_add_f32_dpp v21, v21, v21 row_half_mirror row_mask:0xf bank_mask:0xf
    v_add_f32_dpp v22, v22, v22 row_half_mirror row_mask:0xf bank_mask:0xf
    v_add_f32_dpp v23, v23, v23 row_half_mirror row_mask:0xf bank_mask:0xf
    v_add_f32_dpp v24, v24, v24 row_half_mirror row_mask:0xf bank_mask:0xf
    v_add_f32_dpp v25, v25, v25 row_half_mirror row_mask:0xf bank_mask:0xf
    v_add_f32_dpp v26, v26, v26 row_half_mirror row_mask:0xf bank_mask:0xf
    v_add_f32_dpp v27, v27, v27 row_half_mirror row_mask:0xf bank_mask:0xf
    v_add_f32_dpp v28, v28, v28 row_half_mirror row_mask:0xf bank_mask:0xf
    v_add_f32_dpp v29, v29, v29 row_half_mirror row_mask:0xf bank_mask:0xf
    v_add_f32_dpp v30, v30, v30 row_half_mirror row_mask:0xf bank_mask:0xf
    s_nop 1
    v_add_f32_dpp v12, v12, v12 row_mirror row_mask:0xf bank_mask:0xf
    v_add_f32_dpp v13, v13, v13 row_mirror row_mask:0xf bank_mask:0xf
    v_add_f32_dpp v14, v14, v14 row_mirror row_mask:0xf bank_mask:0xf
    v_add_f32_dpp v15, v15, v15 row_mirror row_mask:0xf bank_mask:0xf
    v_add_f32_dpp v16, v16, v16 row_mirror row_mask:0xf bank_mask:0xf
    v_add_f32_dpp v17, v17, v17 row_mirror row_mask:0xf bank_mask:0xf
    v_add_f32_dpp v18, v18, v18 row_mirror row_mask:0xf bank_mask:0xf
    v_add_f32_dpp v19, v19, v19 row_mirror row_mask:0xf bank_mask:0xf
    v_add_f32_dpp v20, v20, v20 row_mirror row_mask:0xf bank_mask:0xf
    v_add_f32_dpp v21, v21, v21 row_mirror row_mask:0xf bank_mask:0xf
    v_add_f32_dpp v22, v22, v22 row_mirror row_mask:0xf bank_mask:0xf
    v_add_f32_dpp v23, v23, v23 row_mirror row_mask:0xf bank_mask:0xf
    v_add_f32_dpp v24, v24, v24 row_mirror row_mask:0xf bank_mask:0xf
    v_add_f32_dpp v25, v25, v25 row_mirror row_mask:0xf bank_mask:0xf
    v_add_f32_dpp v26, v26, v26 row_mirror row_mask:0xf bank_mask:0xf
    v_add_f32_dpp v27, v27, v27 row_mirror row_mask:0xf bank_mask:0xf
    v_add_f32_dpp v28, v28, v28 row_mirror row_mask:0xf bank_mask:0xf
    v_add_f32_dpp v29, v29, v29 row_mirror row_mask:0xf bank_mask:0xf
    v_add_f32_dpp v30, v30, v30 row_mirror row_mask:0xf bank_mask:0xf
    s_nop 1
    v_mov_b32 v88, v12
    v_mov_b32 v89, v13
    v_mov_b32 v90, v14
    v_mov_b32 v91, v15
    v_mov_b32 v92, v16
    v_mov_b32 v93, v17
    v_mov_b32 v94, v18
    v_mov_b32 v95, v19
    v_mov_b32 v96, v20
    v_mov_b32 v97, v21
    v_mov_b32 v98, v22
    v_mov_b32 v99, v23
    v_mov_b32 v100, v24
    v_mov_b32 v101, v25
    v_mov_b32 v102, v26
    v_mov_b32 v103, v27
    v_mov_b32 v104, v28
    v_mov_b32 v105, v29
    v_mov_b32 v106, v30
    s_nop 1
    v_permlane16_swap_b32 v12, v88
    v_permlane16_swap_b32 v13, v89
    v_permlane16_swap_b32 v14, v90
    v_permlane16_swap_b32 v15, v91
    v_permlane16_swap_b32 v16, v92
    v_permlane16_swap_b32 v17, v93
    v_permlane16_swap_b32 v18, v94
    v_permlane16_swap_b32 v19, v95
    v_permlane16_swap_b32 v20, v96
    v_permlane16_swap_b32 v21, v97
    v_permlane16_swap_b32 v22, v98
    v_permlane16_swap_b32 v23, v99
    v_permlane16_swap_b32 v24, v100
    v_permlane16_swap_b32 v25, v101
    v_permlane16_swap_b32 v26, v102
    v_permlane16_swap_b32 v27, v103
    v_permlane16_swap_b32 v28, v104
    v_permlane16_swap_b32 v29, v105
    v_permlane16_swap_b32 v30, v106
    v_add_f32 v12, v12, v88
    v_add_f32 v13, v13, v89
    v_add_f32 v14, v14, v90
    v_add_f32 v15, v15, v91
    v_add_f32 v16, v16, v92
    v_add_f32 v17, v17, v93
    v_add_f32 v18, v18, v94
    v_add_f32 v19, v19, v95
    v_add_f32 v20, v20, v96
    v_add_f32 v21, v21, v97
    v_add_f32 v22, v22, v98
    v_add_f32 v23, v23, v99
    v_add_f32 v24, v24, v100
    v_add_f32 v25, v25, v101
    v_add_f32 v26, v26, v102
    v_add_f32 v27, v27, v103
    v_add_f32 v28, v28, v104
    v_add_f32 v29, v29, v105
    v_add_f32 v30, v30, v106
    v_cvt_pk_bf16_f32 v2, v12, v12
    v_lshlrev_b32 v12, 16, v2
    v_cvt_pk_bf16_f32 v2, v13, v13
    v_lshlrev_b32 v13, 16, v2
    v_cvt_pk_bf16_f32 v2, v14, v14
    v_lshlrev_b32 v14, 16, v2
    v_cvt_pk_bf16_f32 v2, v15, v15
    v_lshlrev_b32 v15, 16, v2
    v_cvt_pk_bf16_f32 v2, v16, v16
    v_lshlrev_b32 v16, 16, v2
    v_cvt_pk_bf16_f32 v2, v17, v17
    v_lshlrev_b32 v17, 16, v2
    v_cvt_pk_bf16_f32 v2, v18, v18
    v_lshlrev_b32 v18, 16, v2
    v_cvt_pk_bf16_f32 v2, v19, v19
    v_lshlrev_b32 v19, 16, v2
    v_cvt_pk_bf16_f32 v2, v20, v20
    v_lshlrev_b32 v20, 16, v2
    v_cvt_pk_bf16_f32 v2, v21, v21
    v_lshlrev_b32 v21, 16, v2
    v_cvt_pk_bf16_f32 v2, v22, v22
    v_lshlrev_b32 v22, 16, v2
    v_cvt_pk_bf16_f32 v2, v23, v23
    v_lshlrev_b32 v23, 16, v2
    v_cvt_pk_bf16_f32 v2, v24, v24
    v_lshlrev_b32 v24, 16, v2
    v_cvt_pk_bf16_f32 v2, v25, v25
    v_lshlrev_b32 v25, 16, v2
    v_cvt_pk_bf16_f32 v2, v26, v26
    v_lshlrev_b32 v26, 16, v2
    v_cvt_pk_bf16_f32 v2, v27, v27
    v_lshlrev_b32 v27, 16, v2
    v_cvt_pk_bf16_f32 v2, v28, v28
    v_lshlrev_b32 v28, 16, v2
    v_cvt_pk_bf16_f32 v2, v29, v29
    v_lshlrev_b32 v29, 16, v2
    v_cvt_pk_bf16_f32 v2, v30, v30
    v_lshlrev_b32 v30, 16, v2
    s_mov_b32 s62, 0x3db8aa3b
    s_mul_i32 s63, s58, 300032
    s_add_u32 s63, s63, 294912
    s_lshl_b32 s67, s67, 10
    s_add_u32 s63, s63, s67
    s_cmp_ge_u32 s63, s66
    s_cselect_b32 s63, 0xff000000, 0
    v_mul_f32 v12, s62, v12
    v_mul_f32 v13, s62, v13
    v_mul_f32 v14, s62, v14
    v_mul_f32 v15, s62, v15
    v_mul_f32 v16, s62, v16
    v_mul_f32 v17, s62, v17
    v_mul_f32 v18, s62, v18
    v_mul_f32 v19, s62, v19
    v_mul_f32 v20, s62, v20
    v_mul_f32 v21, s62, v21
    v_mul_f32 v22, s62, v22
    v_mul_f32 v23, s62, v23
    v_mul_f32 v24, s62, v24
    v_mul_f32 v25, s62, v25
    v_mul_f32 v26, s62, v26
    v_mul_f32 v27, s62, v27
    v_mul_f32 v28, s62, v28
    v_mul_f32 v29, s62, v29
    v_mul_f32 v30, s62, v30
    v_add_f32 v30, s63, v30
    v_max_f32 v2, v12, v13
    v_max_f32 v2, v2, v14
    v_max_f32 v2, v2, v15
    v_max_f32 v2, v2, v16
    v_max_f32 v2, v2, v17
    v_max_f32 v2, v2, v18
    v_max_f32 v2, v2, v19
    v_max_f32 v2, v2, v20
    v_max_f32 v2, v2, v21
    v_max_f32 v2, v2, v22
    v_max_f32 v2, v2, v23
    v_max_f32 v2, v2, v24
    v_max_f32 v2, v2, v25
    v_max_f32 v2, v2, v26
    v_max_f32 v2, v2, v27
    v_max_f32 v2, v2, v28
    v_max_f32 v2, v2, v29
    v_max_f32 v2, v2, v30
    v_mov_b32 v3, v2
    s_nop 1
    v_permlane32_swap_b32 v2, v3
    v_max_f32 v2, v2, v3
    v_sub_f32 v12, v12, v2
    v_exp_f32 v12, v12
    v_sub_f32 v13, v13, v2
    v_exp_f32 v13, v13
    v_sub_f32 v14, v14, v2
    v_exp_f32 v14, v14
    v_sub_f32 v15, v15, v2
    v_exp_f32 v15, v15
    v_sub_f32 v16, v16, v2
    v_exp_f32 v16, v16
    v_sub_f32 v17, v17, v2
    v_exp_f32 v17, v17
    v_sub_f32 v18, v18, v2
    v_exp_f32 v18, v18
    v_sub_f32 v19, v19, v2
    v_exp_f32 v19, v19
    v_sub_f32 v20, v20, v2
    v_exp_f32 v20, v20
    v_sub_f32 v21, v21, v2
    v_exp_f32 v21, v21
    v_sub_f32 v22, v22, v2
    v_exp_f32 v22, v22
    v_sub_f32 v23, v23, v2
    v_exp_f32 v23, v23
    v_sub_f32 v24, v24, v2
    v_exp_f32 v24, v24
    v_sub_f32 v25, v25, v2
    v_exp_f32 v25, v25
    v_sub_f32 v26, v26, v2
    v_exp_f32 v26, v26
    v_sub_f32 v27, v27, v2
    v_exp_f32 v27, v27
    v_sub_f32 v28, v28, v2
    v_exp_f32 v28, v28
    v_sub_f32 v29, v29, v2
    v_exp_f32 v29, v29
    v_sub_f32 v30, v30, v2
    v_exp_f32 v30, v30
    s_nop 0
    v_add_f32 v3, v12, v13
    v_add_f32 v3, v3, v14
    v_add_f32 v3, v3, v15
    v_add_f32 v3, v3, v16
    v_add_f32 v3, v3, v17
    v_add_f32 v3, v3, v18
    v_add_f32 v3, v3, v19
    v_add_f32 v3, v3, v20
    v_add_f32 v3, v3, v21
    v_add_f32 v3, v3, v22
    v_add_f32 v3, v3, v23
    v_add_f32 v3, v3, v24
    v_add_f32 v3, v3, v25
    v_add_f32 v3, v3, v26
    v_add_f32 v3, v3, v27
    v_add_f32 v3, v3, v28
    v_add_f32 v3, v3, v29
    v_add_f32 v3, v3, v30
    v_mov_b32 v6, v3
    s_nop 1
    v_permlane32_swap_b32 v3, v6
    v_add_f32 v3, v3, v6
    v_mov_b32 v88, 0
    v_mov_b32 v89, 0
    v_mov_b32 v90, 0
    v_mov_b32 v91, 0
    v_mov_b32 v92, 0
    v_mov_b32 v93, 0
    v_mov_b32 v94, 0
    v_mov_b32 v95, 0
    v_and_b32 v7, 63, v0
    v_lshlrev_b32 v7, 4, v7
    v_add_u32 v7, s64, v7
    s_waitcnt vmcnt(18)
    v_lshlrev_b32 v96, 16, v108
    v_and_b32 v97, 0xffff0000, v108
    v_pk_fma_f32 v[88:89], v[96:97], v[12:13], v[88:89] op_sel:[0,0,0] op_sel_hi:[1,0,1]
    v_lshlrev_b32 v96, 16, v109
    v_and_b32 v97, 0xffff0000, v109
    v_pk_fma_f32 v[90:91], v[96:97], v[12:13], v[90:91] op_sel:[0,0,0] op_sel_hi:[1,0,1]
    v_lshlrev_b32 v96, 16, v110
    v_and_b32 v97, 0xffff0000, v110
    v_pk_fma_f32 v[92:93], v[96:97], v[12:13], v[92:93] op_sel:[0,0,0] op_sel_hi:[1,0,1]
    v_lshlrev_b32 v96, 16, v111
    v_and_b32 v97, 0xffff0000, v111
    v_pk_fma_f32 v[94:95], v[96:97], v[12:13], v[94:95] op_sel:[0,0,0] op_sel_hi:[1,0,1]
    s_waitcnt vmcnt(17)
    v_lshlrev_b32 v96, 16, v112
    v_and_b32 v97, 0xffff0000, v112
    v_pk_fma_f32 v[88:89], v[96:97], v[12:13], v[88:89] op_sel:[0,1,0] op_sel_hi:[1,1,1]
    v_lshlrev_b32 v96, 16, v113
    v_and_b32 v97, 0xffff0000, v113
    v_pk_fma_f32 v[90:91], v[96:97], v[12:13], v[90:91] op_sel:[0,1,0] op_sel_hi:[1,1,1]
    v_lshlrev_b32 v96, 16, v114
    v_and_b32 v97, 0xffff0000, v114
    v_pk_fma_f32 v[92:93], v[96:97], v[12:13], v[92:93] op_sel:[0,1,0] op_sel_hi:[1,1,1]
    v_lshlrev_b32 v96, 16, v115
    v_and_b32 v97, 0xffff0000, v115
    v_pk_fma_f32 v[94:95], v[96:97], v[12:13], v[94:95] op_sel:[0,1,0] op_sel_hi:[1,1,1]
    s_waitcnt vmcnt(16)
    v_lshlrev_b32 v96, 16, v116
    v_and_b32 v97, 0xffff0000, v116
    v_pk_fma_f32 v[88:89], v[96:97], v[14:15], v[88:89] op_sel:[0,0,0] op_sel_hi:[1,0,1]
    v_lshlrev_b32 v96, 16, v117
    v_and_b32 v97, 0xffff0000, v117
    v_pk_fma_f32 v[90:91], v[96:97], v[14:15], v[90:91] op_sel:[0,0,0] op_sel_hi:[1,0,1]
    v_lshlrev_b32 v96, 16, v118
    v_and_b32 v97, 0xffff0000, v118
    v_pk_fma_f32 v[92:93], v[96:97], v[14:15], v[92:93] op_sel:[0,0,0] op_sel_hi:[1,0,1]
    v_lshlrev_b32 v96, 16, v119
    v_and_b32 v97, 0xffff0000, v119
    v_pk_fma_f32 v[94:95], v[96:97], v[14:15], v[94:95] op_sel:[0,0,0] op_sel_hi:[1,0,1]
    s_waitcnt vmcnt(15)
    v_lshlrev_b32 v96, 16, v120
    v_and_b32 v97, 0xffff0000, v120
    v_pk_fma_f32 v[88:89], v[96:97], v[14:15], v[88:89] op_sel:[0,1,0] op_sel_hi:[1,1,1]
    v_lshlrev_b32 v96, 16, v121
    v_and_b32 v97, 0xffff0000, v121
    v_pk_fma_f32 v[90:91], v[96:97], v[14:15], v[90:91] op_sel:[0,1,0] op_sel_hi:[1,1,1]
    v_lshlrev_b32 v96, 16, v122
    v_and_b32 v97, 0xffff0000, v122
    v_pk_fma_f32 v[92:93], v[96:97], v[14:15], v[92:93] op_sel:[0,1,0] op_sel_hi:[1,1,1]
    v_lshlrev_b32 v96, 16, v123
    v_and_b32 v97, 0xffff0000, v123
    v_pk_fma_f32 v[94:95], v[96:97], v[14:15], v[94:95] op_sel:[0,1,0] op_sel_hi:[1,1,1]
    s_waitcnt vmcnt(14)
    v_lshlrev_b32 v96, 16, v124
    v_and_b32 v97, 0xffff0000, v124
    v_pk_fma_f32 v[88:89], v[96:97], v[16:17], v[88:89] op_sel:[0,0,0] op_sel_hi:[1,0,1]
    v_lshlrev_b32 v96, 16, v125
    v_and_b32 v97, 0xffff0000, v125
    v_pk_fma_f32 v[90:91], v[96:97], v[16:17], v[90:91] op_sel:[0,0,0] op_sel_hi:[1,0,1]
    v_lshlrev_b32 v96, 16, v126
    v_and_b32 v97, 0xffff0000, v126
    v_pk_fma_f32 v[92:93], v[96:97], v[16:17], v[92:93] op_sel:[0,0,0] op_sel_hi:[1,0,1]
    v_lshlrev_b32 v96, 16, v127
    v_and_b32 v97, 0xffff0000, v127
    v_pk_fma_f32 v[94:95], v[96:97], v[16:17], v[94:95] op_sel:[0,0,0] op_sel_hi:[1,0,1]
    s_waitcnt vmcnt(13)
    v_lshlrev_b32 v96, 16, v32
    v_and_b32 v97, 0xffff0000, v32
    v_pk_fma_f32 v[88:89], v[96:97], v[16:17], v[88:89] op_sel:[0,1,0] op_sel_hi:[1,1,1]
    v_lshlrev_b32 v96, 16, v33
    v_and_b32 v97, 0xffff0000, v33
    v_pk_fma_f32 v[90:91], v[96:97], v[16:17], v[90:91] op_sel:[0,1,0] op_sel_hi:[1,1,1]
    v_lshlrev_b32 v96, 16, v34
    v_and_b32 v97, 0xffff0000, v34
    v_pk_fma_f32 v[92:93], v[96:97], v[16:17], v[92:93] op_sel:[0,1,0] op_sel_hi:[1,1,1]
    v_lshlrev_b32 v96, 16, v35
    v_and_b32 v97, 0xffff0000, v35
    v_pk_fma_f32 v[94:95], v[96:97], v[16:17], v[94:95] op_sel:[0,1,0] op_sel_hi:[1,1,1]
    s_waitcnt vmcnt(12)
    v_lshlrev_b32 v96, 16, v36
    v_and_b32 v97, 0xffff0000, v36
    v_pk_fma_f32 v[88:89], v[96:97], v[18:19], v[88:89] op_sel:[0,0,0] op_sel_hi:[1,0,1]
    v_lshlrev_b32 v96, 16, v37
    v_and_b32 v97, 0xffff0000, v37
    v_pk_fma_f32 v[90:91], v[96:97], v[18:19], v[90:91] op_sel:[0,0,0] op_sel_hi:[1,0,1]
    v_lshlrev_b32 v96, 16, v38
    v_and_b32 v97, 0xffff0000, v38
    v_pk_fma_f32 v[92:93], v[96:97], v[18:19], v[92:93] op_sel:[0,0,0] op_sel_hi:[1,0,1]
    v_lshlrev_b32 v96, 16, v39
    v_and_b32 v97, 0xffff0000, v39
    v_pk_fma_f32 v[94:95], v[96:97], v[18:19], v[94:95] op_sel:[0,0,0] op_sel_hi:[1,0,1]
    s_waitcnt vmcnt(11)
    v_lshlrev_b32 v96, 16, v40
    v_and_b32 v97, 0xffff0000, v40
    v_pk_fma_f32 v[88:89], v[96:97], v[18:19], v[88:89] op_sel:[0,1,0] op_sel_hi:[1,1,1]
    v_lshlrev_b32 v96, 16, v41
    v_and_b32 v97, 0xffff0000, v41
    v_pk_fma_f32 v[90:91], v[96:97], v[18:19], v[90:91] op_sel:[0,1,0] op_sel_hi:[1,1,1]
    v_lshlrev_b32 v96, 16, v42
    v_and_b32 v97, 0xffff0000, v42
    v_pk_fma_f32 v[92:93], v[96:97], v[18:19], v[92:93] op_sel:[0,1,0] op_sel_hi:[1,1,1]
    v_lshlrev_b32 v96, 16, v43
    v_and_b32 v97, 0xffff0000, v43
    v_pk_fma_f32 v[94:95], v[96:97], v[18:19], v[94:95] op_sel:[0,1,0] op_sel_hi:[1,1,1]
    s_waitcnt vmcnt(10)
    v_lshlrev_b32 v96, 16, v44
    v_and_b32 v97, 0xffff0000, v44
    v_pk_fma_f32 v[88:89], v[96:97], v[20:21], v[88:89] op_sel:[0,0,0] op_sel_hi:[1,0,1]
    v_lshlrev_b32 v96, 16, v45
    v_and_b32 v97, 0xffff0000, v45
    v_pk_fma_f32 v[90:91], v[96:97], v[20:21], v[90:91] op_sel:[0,0,0] op_sel_hi:[1,0,1]
    v_lshlrev_b32 v96, 16, v46
    v_and_b32 v97, 0xffff0000, v46
    v_pk_fma_f32 v[92:93], v[96:97], v[20:21], v[92:93] op_sel:[0,0,0] op_sel_hi:[1,0,1]
    v_lshlrev_b32 v96, 16, v47
    v_and_b32 v97, 0xffff0000, v47
    v_pk_fma_f32 v[94:95], v[96:97], v[20:21], v[94:95] op_sel:[0,0,0] op_sel_hi:[1,0,1]
    s_waitcnt vmcnt(9)
    v_lshlrev_b32 v96, 16, v48
    v_and_b32 v97, 0xffff0000, v48
    v_pk_fma_f32 v[88:89], v[96:97], v[20:21], v[88:89] op_sel:[0,1,0] op_sel_hi:[1,1,1]
    v_lshlrev_b32 v96, 16, v49
    v_and_b32 v97, 0xffff0000, v49
    v_pk_fma_f32 v[90:91], v[96:97], v[20:21], v[90:91] op_sel:[0,1,0] op_sel_hi:[1,1,1]
    v_lshlrev_b32 v96, 16, v50
    v_and_b32 v97, 0xffff0000, v50
    v_pk_fma_f32 v[92:93], v[96:97], v[20:21], v[92:93] op_sel:[0,1,0] op_sel_hi:[1,1,1]
    v_lshlrev_b32 v96, 16, v51
    v_and_b32 v97, 0xffff0000, v51
    v_pk_fma_f32 v[94:95], v[96:97], v[20:21], v[94:95] op_sel:[0,1,0] op_sel_hi:[1,1,1]
    s_waitcnt vmcnt(8)
    v_lshlrev_b32 v96, 16, v52
    v_and_b32 v97, 0xffff0000, v52
    v_pk_fma_f32 v[88:89], v[96:97], v[22:23], v[88:89] op_sel:[0,0,0] op_sel_hi:[1,0,1]
    v_lshlrev_b32 v96, 16, v53
    v_and_b32 v97, 0xffff0000, v53
    v_pk_fma_f32 v[90:91], v[96:97], v[22:23], v[90:91] op_sel:[0,0,0] op_sel_hi:[1,0,1]
    v_lshlrev_b32 v96, 16, v54
    v_and_b32 v97, 0xffff0000, v54
    v_pk_fma_f32 v[92:93], v[96:97], v[22:23], v[92:93] op_sel:[0,0,0] op_sel_hi:[1,0,1]
    v_lshlrev_b32 v96, 16, v55
    v_and_b32 v97, 0xffff0000, v55
    v_pk_fma_f32 v[94:95], v[96:97], v[22:23], v[94:95] op_sel:[0,0,0] op_sel_hi:[1,0,1]
    s_waitcnt vmcnt(7)
    v_lshlrev_b32 v96, 16, v56
    v_and_b32 v97, 0xffff0000, v56
    v_pk_fma_f32 v[88:89], v[96:97], v[22:23], v[88:89] op_sel:[0,1,0] op_sel_hi:[1,1,1]
    v_lshlrev_b32 v96, 16, v57
    v_and_b32 v97, 0xffff0000, v57
    v_pk_fma_f32 v[90:91], v[96:97], v[22:23], v[90:91] op_sel:[0,1,0] op_sel_hi:[1,1,1]
    v_lshlrev_b32 v96, 16, v58
    v_and_b32 v97, 0xffff0000, v58
    v_pk_fma_f32 v[92:93], v[96:97], v[22:23], v[92:93] op_sel:[0,1,0] op_sel_hi:[1,1,1]
    v_lshlrev_b32 v96, 16, v59
    v_and_b32 v97, 0xffff0000, v59
    v_pk_fma_f32 v[94:95], v[96:97], v[22:23], v[94:95] op_sel:[0,1,0] op_sel_hi:[1,1,1]
    s_waitcnt vmcnt(6)
    v_lshlrev_b32 v96, 16, v60
    v_and_b32 v97, 0xffff0000, v60
    v_pk_fma_f32 v[88:89], v[96:97], v[24:25], v[88:89] op_sel:[0,0,0] op_sel_hi:[1,0,1]
    v_lshlrev_b32 v96, 16, v61
    v_and_b32 v97, 0xffff0000, v61
    v_pk_fma_f32 v[90:91], v[96:97], v[24:25], v[90:91] op_sel:[0,0,0] op_sel_hi:[1,0,1]
    v_lshlrev_b32 v96, 16, v62
    v_and_b32 v97, 0xffff0000, v62
    v_pk_fma_f32 v[92:93], v[96:97], v[24:25], v[92:93] op_sel:[0,0,0] op_sel_hi:[1,0,1]
    v_lshlrev_b32 v96, 16, v63
    v_and_b32 v97, 0xffff0000, v63
    v_pk_fma_f32 v[94:95], v[96:97], v[24:25], v[94:95] op_sel:[0,0,0] op_sel_hi:[1,0,1]
    s_waitcnt vmcnt(5)
    v_lshlrev_b32 v96, 16, v64
    v_and_b32 v97, 0xffff0000, v64
    v_pk_fma_f32 v[88:89], v[96:97], v[24:25], v[88:89] op_sel:[0,1,0] op_sel_hi:[1,1,1]
    v_lshlrev_b32 v96, 16, v65
    v_and_b32 v97, 0xffff0000, v65
    v_pk_fma_f32 v[90:91], v[96:97], v[24:25], v[90:91] op_sel:[0,1,0] op_sel_hi:[1,1,1]
    v_lshlrev_b32 v96, 16, v66
    v_and_b32 v97, 0xffff0000, v66
    v_pk_fma_f32 v[92:93], v[96:97], v[24:25], v[92:93] op_sel:[0,1,0] op_sel_hi:[1,1,1]
    v_lshlrev_b32 v96, 16, v67
    v_and_b32 v97, 0xffff0000, v67
    v_pk_fma_f32 v[94:95], v[96:97], v[24:25], v[94:95] op_sel:[0,1,0] op_sel_hi:[1,1,1]
    s_waitcnt vmcnt(4)
    v_lshlrev_b32 v96, 16, v68
    v_and_b32 v97, 0xffff0000, v68
    v_pk_fma_f32 v[88:89], v[96:97], v[26:27], v[88:89] op_sel:[0,0,0] op_sel_hi:[1,0,1]
    v_lshlrev_b32 v96, 16, v69
    v_and_b32 v97, 0xffff0000, v69
    v_pk_fma_f32 v[90:91], v[96:97], v[26:27], v[90:91] op_sel:[0,0,0] op_sel_hi:[1,0,1]
    v_lshlrev_b32 v96, 16, v70
    v_and_b32 v97, 0xffff0000, v70
    v_pk_fma_f32 v[92:93], v[96:97], v[26:27], v[92:93] op_sel:[0,0,0] op_sel_hi:[1,0,1]
    v_lshlrev_b32 v96, 16, v71
    v_and_b32 v97, 0xffff0000, v71
    v_pk_fma_f32 v[94:95], v[96:97], v[26:27], v[94:95] op_sel:[0,0,0] op_sel_hi:[1,0,1]
    s_waitcnt vmcnt(3)
    v_lshlrev_b32 v96, 16, v72
    v_and_b32 v97, 0xffff0000, v72
    v_pk_fma_f32 v[88:89], v[96:97], v[26:27], v[88:89] op_sel:[0,1,0] op_sel_hi:[1,1,1]
    v_lshlrev_b32 v96, 16, v73
    v_and_b32 v97, 0xffff0000, v73
    v_pk_fma_f32 v[90:91], v[96:97], v[26:27], v[90:91] op_sel:[0,1,0] op_sel_hi:[1,1,1]
    v_lshlrev_b32 v96, 16, v74
    v_and_b32 v97, 0xffff0000, v74
    v_pk_fma_f32 v[92:93], v[96:97], v[26:27], v[92:93] op_sel:[0,1,0] op_sel_hi:[1,1,1]
    v_lshlrev_b32 v96, 16, v75
    v_and_b32 v97, 0xffff0000, v75
    v_pk_fma_f32 v[94:95], v[96:97], v[26:27], v[94:95] op_sel:[0,1,0] op_sel_hi:[1,1,1]
    s_waitcnt vmcnt(2)
    v_lshlrev_b32 v96, 16, v76
    v_and_b32 v97, 0xffff0000, v76
    v_pk_fma_f32 v[88:89], v[96:97], v[28:29], v[88:89] op_sel:[0,0,0] op_sel_hi:[1,0,1]
    v_lshlrev_b32 v96, 16, v77
    v_and_b32 v97, 0xffff0000, v77
    v_pk_fma_f32 v[90:91], v[96:97], v[28:29], v[90:91] op_sel:[0,0,0] op_sel_hi:[1,0,1]
    v_lshlrev_b32 v96, 16, v78
    v_and_b32 v97, 0xffff0000, v78
    v_pk_fma_f32 v[92:93], v[96:97], v[28:29], v[92:93] op_sel:[0,0,0] op_sel_hi:[1,0,1]
    v_lshlrev_b32 v96, 16, v79
    v_and_b32 v97, 0xffff0000, v79
    v_pk_fma_f32 v[94:95], v[96:97], v[28:29], v[94:95] op_sel:[0,0,0] op_sel_hi:[1,0,1]
    s_waitcnt vmcnt(1)
    v_lshlrev_b32 v96, 16, v80
    v_and_b32 v97, 0xffff0000, v80
    v_pk_fma_f32 v[88:89], v[96:97], v[28:29], v[88:89] op_sel:[0,1,0] op_sel_hi:[1,1,1]
    v_lshlrev_b32 v96, 16, v81
    v_and_b32 v97, 0xffff0000, v81
    v_pk_fma_f32 v[90:91], v[96:97], v[28:29], v[90:91] op_sel:[0,1,0] op_sel_hi:[1,1,1]
    v_lshlrev_b32 v96, 16, v82
    v_and_b32 v97, 0xffff0000, v82
    v_pk_fma_f32 v[92:93], v[96:97], v[28:29], v[92:93] op_sel:[0,1,0] op_sel_hi:[1,1,1]
    v_lshlrev_b32 v96, 16, v83
    v_and_b32 v97, 0xffff0000, v83
    v_pk_fma_f32 v[94:95], v[96:97], v[28:29], v[94:95] op_sel:[0,1,0] op_sel_hi:[1,1,1]
    s_waitcnt vmcnt(0)
    v_lshlrev_b32 v96, 16, v84
    v_and_b32 v97, 0xffff0000, v84
    v_pk_fma_f32 v[88:89], v[96:97], v[30:31], v[88:89] op_sel:[0,0,0] op_sel_hi:[1,0,1]
    v_lshlrev_b32 v96, 16, v85
    v_and_b32 v97, 0xffff0000, v85
    v_pk_fma_f32 v[90:91], v[96:97], v[30:31], v[90:91] op_sel:[0,0,0] op_sel_hi:[1,0,1]
    v_lshlrev_b32 v96, 16, v86
    v_and_b32 v97, 0xffff0000, v86
    v_pk_fma_f32 v[92:93], v[96:97], v[30:31], v[92:93] op_sel:[0,0,0] op_sel_hi:[1,0,1]
    v_lshlrev_b32 v96, 16, v87
    v_and_b32 v97, 0xffff0000, v87
    v_pk_fma_f32 v[94:95], v[96:97], v[30:31], v[94:95] op_sel:[0,0,0] op_sel_hi:[1,0,1]
    s_nop 1
    v_permlane32_swap_b32 v88, v92
    v_permlane32_swap_b32 v89, v93
    v_permlane32_swap_b32 v90, v94
    v_permlane32_swap_b32 v91, v95
    v_add_f32 v88, v88, v92
    v_add_f32 v89, v89, v93
    v_add_f32 v90, v90, v94
    v_add_f32 v91, v91, v95
    v_and_b32 v4, 31, v0
    v_lshlrev_b32 v4, 5, v4
    v_bfe_u32 v5, v0, 5, 1
    v_lshl_add_u32 v4, v5, 4, v4
    v_lshrrev_b32 v5, 6, v0
    v_lshl_add_u32 v4, v5, 10, v4
    ds_write_b128 v4, v[88:91]
    v_lshlrev_b32 v5, 3, v5
    ds_write_b64 v5, v[2:3] offset:16384
    s_waitcnt lgkmcnt(0)
    s_barrier
    v_cmp_gt_u32 vcc, 128, v0
    s_and_saveexec_b64 s[60:61], vcc
    s_cbranch_execz L_st_end
    v_mov_b32 v5, 0
    ds_read_b128 v[32:35], v5 offset:16384
    ds_read_b128 v[36:39], v5 offset:16400
    ds_read_b128 v[40:43], v5 offset:16416
    ds_read_b128 v[44:47], v5 offset:16432
    ds_read_b128 v[48:51], v5 offset:16448
    ds_read_b128 v[52:55], v5 offset:16464
    ds_read_b128 v[56:59], v5 offset:16480
    ds_read_b128 v[60:63], v5 offset:16496
    v_lshlrev_b32 v4, 3, v0
    ds_read_b64 v[64:65], v4 offset:0
    ds_read_b64 v[66:67], v4 offset:1024
    ds_read_b64 v[68:69], v4 offset:2048
    ds_read_b64 v[70:71], v4 offset:3072
    ds_read_b64 v[72:73], v4 offset:4096
    ds_read_b64 v[74:75], v4 offset:5120
    ds_read_b64 v[76:77], v4 offset:6144
    ds_read_b64 v[78:79], v4 offset:7168
    ds_read_b64 v[80:81], v4 offset:8192
    ds_read_b64 v[82:83], v4 offset:9216
    ds_read_b64 v[84:85], v4 offset:10240
    ds_read_b64 v[86:87], v4 offset:11264
    ds_read_b64 v[88:89], v4 offset:12288
    ds_read_b64 v[90:91], v4 offset:13312
    ds_read_b64 v[92:93], v4 offset:14336
    ds_read_b64 v[94:95], v4 offset:15360
    s_waitcnt lgkmcnt(0)
    v_max_f32 v8, v32, v34
    v_max_f32 v8, v8, v36
    v_max_f32 v8, v8, v38
    v_max_f32 v8, v8, v40
    v_max_f32 v8, v8, v42
    v_max_f32 v8, v8, v44
    v_max_f32 v8, v8, v46
    v_max_f32 v8, v8, v48
    v_max_f32 v8, v8, v50
    v_max_f32 v8, v8, v52
    v_max_f32 v8, v8, v54
    v_max_f32 v8, v8, v56
    v_max_f32 v8, v8, v58
    v_max_f32 v8, v8, v60
    v_max_f32 v8, v8, v62
    v_mov_b32 v9, 0
    v_mov_b32 v12, 0
    v_mov_b32 v13, 0
    v_sub_f32 v11, v32, v8
    v_exp_f32 v11, v11
    s_nop 0
    v_fmac_f32 v9, v11, v33
    v_fmac_f32 v12, v11, v64
    v_fmac_f32 v13, v11, v65
    v_sub_f32 v11, v34, v8
    v_exp_f32 v11, v11
    s_nop 0
    v_fmac_f32 v9, v11, v35
    v_fmac_f32 v12, v11, v66
    v_fmac_f32 v13, v11, v67
    v_sub_f32 v11, v36, v8
    v_exp_f32 v11, v11
    s_nop 0
    v_fmac_f32 v9, v11, v37
    v_fmac_f32 v12, v11, v68
    v_fmac_f32 v13, v11, v69
    v_sub_f32 v11, v38, v8
    v_exp_f32 v11, v11
    s_nop 0
    v_fmac_f32 v9, v11, v39
    v_fmac_f32 v12, v11, v70
    v_fmac_f32 v13, v11, v71
    v_sub_f32 v11, v40, v8
    v_exp_f32 v11, v11
    s_nop 0
    v_fmac_f32 v9, v11, v41
    v_fmac_f32 v12, v11, v72
    v_fmac_f32 v13, v11, v73
    v_sub_f32 v11, v42, v8
    v_exp_f32 v11, v11
    s_nop 0
    v_fmac_f32 v9, v11, v43
    v_fmac_f32 v12, v11, v74
    v_fmac_f32 v13, v11, v75
    v_sub_f32 v11, v44, v8
    v_exp_f32 v11, v11
    s_nop 0
    v_fmac_f32 v9, v11, v45
    v_fmac_f32 v12, v11, v76
    v_fmac_f32 v13, v11, v77
    v_sub_f32 v11, v46, v8
    v_exp_f32 v11, v11
    s_nop 0
    v_fmac_f32 v9, v11, v47
    v_fmac_f32 v12, v11, v78
    v_fmac_f32 v13, v11, v79
    v_sub_f32 v11, v48, v8
    v_exp_f32 v11, v11
    s_nop 0
    v_fmac_f32 v9, v11, v49
    v_fmac_f32 v12, v11, v80
    v_fmac_f32 v13, v11, v81
    v_sub_f32 v11, v50, v8
    v_exp_f32 v11, v11
    s_nop 0
    v_fmac_f32 v9, v11, v51
    v_fmac_f32 v12, v11, v82
    v_fmac_f32 v13, v11, v83
    v_sub_f32 v11, v52, v8
    v_exp_f32 v11, v11
    s_nop 0
    v_fmac_f32 v9, v11, v53
    v_fmac_f32 v12, v11, v84
    v_fmac_f32 v13, v11, v85
    v_sub_f32 v11, v54, v8
    v_exp_f32 v11, v11
    s_nop 0
    v_fmac_f32 v9, v11, v55
    v_fmac_f32 v12, v11, v86
    v_fmac_f32 v13, v11, v87
    v_sub_f32 v11, v56, v8
    v_exp_f32 v11, v11
    s_nop 0
    v_fmac_f32 v9, v11, v57
    v_fmac_f32 v12, v11, v88
    v_fmac_f32 v13, v11, v89
    v_sub_f32 v11, v58, v8
    v_exp_f32 v11, v11
    s_nop 0
    v_fmac_f32 v9, v11, v59
    v_fmac_f32 v12, v11, v90
    v_fmac_f32 v13, v11, v91
    v_sub_f32 v11, v60, v8
    v_exp_f32 v11, v11
    s_nop 0
    v_fmac_f32 v9, v11, v61
    v_fmac_f32 v12, v11, v92
    v_fmac_f32 v13, v11, v93
    v_sub_f32 v11, v62, v8
    v_exp_f32 v11, v11
    s_nop 0
    v_fmac_f32 v9, v11, v63
    v_fmac_f32 v12, v11, v94
    v_fmac_f32 v13, v11, v95
    s_mul_i32 s56, s56, 2112
    s_add_u32 s56, s56, 131072
    v_lshlrev_b32 v4, 4, v0
    v_add_u32 v4, s56, v4
    v_mov_b32 v14, s80
    v_mov_b32 v15, s81
    v_mov_b32 v10, s80
    v_mov_b32 v11, s81
    global_store_dwordx4 v4, v[12:15], s[42:43] sc1
    v_cmp_eq_u32 vcc, 0, v0
    s_and_b64 exec, exec, vcc
    global_store_dwordx4 v4, v[8:11], s[42:43] offset:2048 sc1
L_st_end:
    s_mov_b64 exec, s[60:61]
    s_endpgm
L_exit:
    s_endpgm

.section .rodata,"a"
.p2align 6
.amdhsa_kernel adaLN_cond__mha_block_cached__geglu_ffn__decode_kernel
  .amdhsa_next_free_vgpr 128
  .amdhsa_next_free_sgpr 102
  .amdhsa_accum_offset 128
  .amdhsa_group_segment_fixed_size 0
  .amdhsa_kernarg_size 112
  .amdhsa_user_sgpr_count 2
  .amdhsa_user_sgpr_kernarg_segment_ptr 1
  .amdhsa_system_sgpr_workgroup_id_x 1
.end_amdhsa_kernel
```
